```python
import torch

def _softmax(x, axis=-1):
    return torch.softmax(x, dim=axis)
def _gelu(x):
    return torch.nn.functional.gelu(x, approximate="tanh")
def _silu(x):
    return torch.nn.functional.silu(x)
def _sigmoid(x):
    return torch.sigmoid(x)
def _layernorm(x, axis=-1, eps=1e-5):
    m = x.mean(dim=axis, keepdim=True)
    v = x.var(dim=axis, keepdim=True, unbiased=False)
    return (x - m) / torch.sqrt(v + eps)
def _scatter_add(tgt, idx, src, axis=0):
    return tgt.clone().index_add_(axis, idx, src)
def _segment_sum(src, seg, n):
    out = torch.zeros((n,) + src.shape[1:], dtype=src.dtype)
    return out.index_add_(0, seg, src)
def _pad(x, pw):
    flat = tuple(v for pair in reversed(pw) for v in pair)
    return torch.nn.functional.pad(x, flat)

kernel_name = 'interleave_layers__linear_attn_block__glu_gated_bilinear__prompt'

def setup_inputs():

    _w = (lambda a: (lambda t: t.to(torch.bfloat16) if t.is_floating_point() else t)(torch.as_tensor(a)))
    def _A_setup():
        B, S, D = 1, 2048, 512
        return {
            "x": _w((lambda *s: torch.randn(*s, dtype=torch.bfloat16) * 0.05)(B, S, D)),
            "wqkv": _w((lambda *s: torch.randn(*s, dtype=torch.bfloat16) * 0.05)(D, 3 * D)),
            "wo": _w((lambda *s: torch.randn(*s, dtype=torch.bfloat16) * 0.05)(D, D)),
        }
    _A_in = _A_setup()

    def _B_setup():
        B, S, D, F = 1, 2048, 512, 1792
        return {
            "x": _w((lambda *s: torch.randn(*s, dtype=torch.bfloat16) * 0.05)(B, S, D)),
            "w_gate": _w((lambda *s: torch.randn(*s, dtype=torch.bfloat16) * 0.4)(D, F) * (D ** -0.5)),
            "w_up": _w((lambda *s: torch.randn(*s, dtype=torch.bfloat16) * 0.4)(D, F) * (D ** -0.5)),
            "w_down": _w((lambda *s: torch.randn(*s, dtype=torch.bfloat16) * 0.4)(F, D) * (F ** -0.5)),
        }
    _B_in = _B_setup()

    return {
        "A_x": _A_in["x"],
        "A_wqkv": _A_in["wqkv"],
        "A_wo": _A_in["wo"],
        "B_x": _B_in["x"],
        "B_w_gate": _B_in["w_gate"],
        "B_w_up": _B_in["w_up"],
        "B_w_down": _B_in["w_down"],
    }

def reference(A_x, A_wqkv, A_wo, B_x, B_w_gate, B_w_up, B_w_down):
    def _A_ref(x, wqkv, wo):
        B, S, D = x.shape
        H = 32; Dh = D // H
        qkv = (lambda x, *d: x.permute(*d))((x @ wqkv).reshape(B, S, 3, H, Dh), 2, 0, 3, 1, 4)
        q, k, v = qkv[0], qkv[1], qkv[2]
        phi = lambda t: torch.where(t > 0, t + 1, torch.exp(t)) + 1e-6
        pq, pk = phi(q), phi(k)
        kv = torch.einsum("bhsd,bhse->bhde", pk, v)
        z = torch.einsum("bhsd->bhd", pk)
        num = torch.einsum("bhqd,bhde->bhqe", pq, kv)
        den = torch.einsum("bhqd,bhd->bhq", pq, z)[..., None] + 1e-6
        o = num / den
        return (lambda x, *d: x.permute(*d))(o, 0, 2, 1, 3).reshape(B, S, D) @ wo

    def _B_ref(x, w_gate, w_up, w_down):
        g = torch.einsum("bsd,df->bsf", x, w_gate)
        u = torch.einsum("bsd,df->bsf", x, w_up)
        h = g * u
        return torch.einsum("bsf,fd->bsd", h, w_down)

    x = A_x
    x = x + _A_ref(_layernorm(x, axis=-1), A_wqkv, A_wo)
    x = x + _B_ref(_layernorm(x, axis=-1), B_w_gate, B_w_up, B_w_down)
    x = x + _A_ref(_layernorm(x, axis=-1), A_wqkv, A_wo)
    x = x + _B_ref(_layernorm(x, axis=-1), B_w_gate, B_w_up, B_w_down)
    return x
```

```asm
; @launch grid=(256,1,1) block=(256,1,1) lds=163840
.amdgcn_target "amdgcn-amd-amdhsa--gfx950"
.text
.globl interleave_layers__linear_attn_block__glu_gated_bilinear__prompt_kernel
.p2align 8
.type interleave_layers__linear_attn_block__glu_gated_bilinear__prompt_kernel,@function
interleave_layers__linear_attn_block__glu_gated_bilinear__prompt_kernel:
  s_cmp_ge_u32 s2, 256
  s_cbranch_scc1 M_exit
  s_load_dwordx16 s[76:91], s[0:1], 0
  s_load_dwordx4 s[92:95], s[0:1], 64
  v_lshrrev_b32 v16, 6, v0
  v_and_b32 v0, 63, v0
  v_readfirstlane_b32 s14, v16
  s_mov_b32 s6, 37748736
  s_mov_b32 s7, 0x20000
  s_mov_b32 s10, 2097152
  s_mov_b32 s11, 0x20000
  s_mov_b32 s63, 0x20000
  s_and_b32 s40, s2, 7
  s_lshr_b32 s41, s2, 3
  s_lshr_b32 s42, s40, 1
  s_and_b32 s43, s40, 1
  s_lshr_b32 s44, s41, 2
  s_lshr_b32 s17, s40, 2
  s_lshl_b32 s17, s17, 3
  s_add_u32 s17, s17, s44
  s_and_b32 s44, s41, 3
  s_and_b32 s18, s40, 3
  s_lshl_b32 s18, s18, 2
  s_add_u32 s18, s18, s44
  s_lshr_b32 s44, s41, 3
  s_lshl_b32 s19, s40, 2
  s_add_u32 s19, s19, s44
  s_and_b32 s20, s41, 7
  s_lshl_b32 s21, s17, 2
  s_add_u32 s21, s21, s14
  s_lshl_b32 s22, s14, 13
  s_lshl_b32 s23, s14, 10
  s_mul_i32 s24, s14, 9216
  s_lshl_b32 s31, s14, 11
  s_mov_b32 s15, 0
  s_mov_b32 s16, 8388608
  v_lshlrev_b32 v1, 4, v0
  v_and_b32 v16, 7, v0
  v_bfe_u32 v17, v0, 3, 2
  v_lshrrev_b32 v18, 5, v0
  v_and_b32 v19, 31, v0
  v_lshlrev_b32_e64 v21, 10, v16
  v_lshl_add_u32 v21, v17, 5, v21
  v_lshl_add_u32 v23, v18, 3, v21
  s_and_b32 s39, s14, 1
  s_mov_b32 s68, 0
  v_lshrrev_b32_e64 v4, 2, v0
  v_mul_u32_u24 v4, 3072, v4
  v_and_b32_e64 v20, 3, v0
  v_lshl_add_u32 v4, v20, 4, v4
  v_lshrrev_b32 v5, 3, v0
  v_lshlrev_b32 v5, 10, v5
  v_lshl_add_u32 v5, v16, 4, v5
  v_lshlrev_b32 v24, 21, v0
  v_lshlrev_b32 v26, 7, v0
  v_add_u32_e64 v26, s22, v26
  v_min_u32 v26, M_exit-M_pc, v26
  s_getpc_b64 s[58:59]
M_pc:
  s_lshl_b32 s26, s17, 1
  s_add_u32 s26, s26, s18
  s_and_b32 s26, s26, 7
  s_lshl_b32 s44, s26, 1
  s_add_u32 s44, s44, s14
  s_lshl_b32 s44, s44, 1
  s_lshl_b32 s45, s18, 6
  s_add_u32 s46, s44, 0
  s_and_b32 s46, s46, 31
  s_mul_i32 s54, s46, 49152
  s_add_u32 s54, s54, s45
  s_add_u32 s46, s44, 8
  s_and_b32 s46, s46, 31
  s_mul_i32 s55, s46, 49152
  s_add_u32 s55, s55, s45
  s_add_u32 s46, s44, 16
  s_and_b32 s46, s46, 31
  s_mul_i32 s56, s46, 49152
  s_add_u32 s56, s56, s45
  s_add_u32 s46, s44, 24
  s_and_b32 s46, s46, 31
  s_mul_i32 s57, s46, 49152
  s_add_u32 s57, s57, s45
  s_lshl_b32 s50, s21, 15
  s_mov_b32 s42, 1572864
  s_mov_b32 s43, 0x20000
  s_mov_b32 s51, 0
  s_waitcnt lgkmcnt(0)
  s_mov_b32 s4, s94
  s_mov_b32 s5, s95
  s_mov_b32 s8, s76
  s_mov_b32 s9, s77
  s_mov_b32 s40, s78
  s_mov_b32 s41, s79
  s_mov_b32 s74, s92
  s_mov_b32 s75, s93
  s_cmp_lt_u32 s2, 229
  s_cbranch_scc1 P_nz
  s_cmp_lg_u32 s14, 3
  s_cbranch_scc1 P_nz
  v_mov_b32 v36, 0
  v_mov_b32 v37, 0
  v_mov_b32 v38, 0
  v_mov_b32 v39, 0
  s_sub_u32 s45, s2, 229
  s_lshl_b32 s48, s45, 13
  s_cmp_ge_u32 s48, 110592
  s_cselect_b32 s49, 14569472, 0
  s_add_u32 s49, s49, s48
  s_add_u32 s49, s49, 10747904
  buffer_store_dwordx4 v[36:39], v1, s[4:7], s49 offen offset:0 sc0 sc1
  buffer_store_dwordx4 v[36:39], v1, s[4:7], s49 offen offset:1024 sc0 sc1
  buffer_store_dwordx4 v[36:39], v1, s[4:7], s49 offen offset:2048 sc0 sc1
  buffer_store_dwordx4 v[36:39], v1, s[4:7], s49 offen offset:3072 sc0 sc1
  s_add_u32 s48, s48, 4096
  s_cmp_ge_u32 s48, 110592
  s_cselect_b32 s49, 14569472, 0
  s_add_u32 s49, s49, s48
  s_add_u32 s49, s49, 10747904
  buffer_store_dwordx4 v[36:39], v1, s[4:7], s49 offen offset:0 sc0 sc1
  buffer_store_dwordx4 v[36:39], v1, s[4:7], s49 offen offset:1024 sc0 sc1
  buffer_store_dwordx4 v[36:39], v1, s[4:7], s49 offen offset:2048 sc0 sc1
  buffer_store_dwordx4 v[36:39], v1, s[4:7], s49 offen offset:3072 sc0 sc1
  s_add_u32 s48, s48, 4096
  s_mov_b32 s51, 1
P_nz:
  s_add_u32 s46, s54, 1024
  s_add_u32 m0, s31, 0
  s_nop 0
  buffer_load_dwordx4 v4, s[40:43], s46 offen lds
  s_add_u32 s46, s54, 49152
  s_add_u32 m0, s31, 0
  s_nop 0
  buffer_load_dwordx4 v4, s[40:43], s46 offen offset:1024 lds
  s_add_u32 s46, s54, 2048
  s_add_u32 m0, s31, 32768
  s_nop 0
  buffer_load_dwordx4 v4, s[40:43], s46 offen lds
  s_add_u32 s46, s54, 50176
  s_add_u32 m0, s31, 32768
  s_nop 0
  buffer_load_dwordx4 v4, s[40:43], s46 offen offset:1024 lds
  s_add_u32 s52, s26, 0
  s_and_b32 s52, s52, 7
  s_lshl_b32 s52, s52, 7
  s_add_u32 s52, s52, s50
  buffer_load_dwordx4 v[128:131], v5, s[8:11], s52 offen
  s_add_u32 s52, s52, 0x2000
  buffer_load_dwordx4 v[132:135], v5, s[8:11], s52 offen
  s_add_u32 s52, s52, 0x2000
  buffer_load_dwordx4 v[136:139], v5, s[8:11], s52 offen
  s_add_u32 s52, s52, 0x2000
  buffer_load_dwordx4 v[140:143], v5, s[8:11], s52 offen
  s_add_u32 s52, s26, 1
  s_and_b32 s52, s52, 7
  s_lshl_b32 s52, s52, 7
  s_add_u32 s52, s52, s50
  buffer_load_dwordx4 v[144:147], v5, s[8:11], s52 offen
  s_add_u32 s52, s52, 0x2000
  buffer_load_dwordx4 v[148:151], v5, s[8:11], s52 offen
  s_add_u32 s52, s52, 0x2000
  buffer_load_dwordx4 v[152:155], v5, s[8:11], s52 offen
  s_add_u32 s52, s52, 0x2000
  buffer_load_dwordx4 v[156:159], v5, s[8:11], s52 offen
  buffer_load_dword v25, v24, s[4:7], 0 offen sc1
  global_load_dword v25, v26, s[58:59]
  s_mov_b32 s73, 2
  s_mov_b32 s60, s88
  s_mov_b32 s61, s89
  s_mov_b32 s62, 1835008
  s_movk_i32 s65, 1024
  s_lshl_b32 s3, s2, 1
  s_add_u32 s3, s3, s39
  s_and_b32 s47, s3, 7
  s_lshr_b32 s48, s3, 3
  s_lshl_b32 s64, s48, 15
  s_lshl_b32 s44, s47, 7
  s_add_u32 s64, s64, s44
  s_mul_i32 s66, s47, 229376
  s_lshl_b32 s44, s48, 12
  s_add_u32 s66, s66, s44
  s_add_u32 s66, s66, 6553600
  s_cmp_ge_u32 s2, 224
  s_cbranch_scc1 P_w
  s_mov_b32 s73, 3
  s_cmp_ge_u32 s14, 2
  s_cbranch_scc1 P_w
  s_mov_b32 s73, 1
  s_mov_b32 s3, s2
  s_mov_b32 s60, s84
  s_mov_b32 s61, s85
  s_mov_b32 s45, 0
  s_cmp_lt_u32 s3, 112
  s_cbranch_scc1 P_gu2
  s_sub_u32 s3, s3, 112
  s_mov_b32 s60, s86
  s_mov_b32 s61, s87
  s_movk_i32 s45, 256
P_gu2:
  s_mov_b32 s62, 1835008
  s_lshr_b32 s47, s3, 2
  s_and_b32 s48, s3, 3
  s_movk_i32 s65, 3584
  s_lshl_b32 s66, s47, 17
  s_lshl_b32 s44, s48, 13
  s_add_u32 s66, s66, s44
  s_add_u32 s66, s66, s45
  s_add_u32 s66, s66, 2621440
  s_lshl_b32 s68, s47, 12
  s_add_u32 s68, s68, s45
  s_add_u32 s68, s68, 6291456
  s_lshl_b32 s64, s48, 1
  s_add_u32 s64, s64, s39
  s_mul_i32 s64, s64, s65
  s_lshl_b32 s64, s64, 6
  s_lshl_b32 s44, s47, 7
  s_add_u32 s64, s64, s44
  s_lshl_b32 s44, s39, 16
  s_add_u32 s66, s66, s44
  s_lshl_b32 s44, s39, 11
  s_add_u32 s68, s68, s44
  s_lshr_b32 s44, s48, 1
  s_lshl_b32 s44, s44, 9
  s_add_u32 s68, s68, s44
  s_and_b32 s44, s48, 1
  s_lshl_b32 s44, s44, 3
  s_add_u32 s68, s68, s44
P_w:
  s_mov_b32 s72, s90
  s_mov_b32 s3, s91
  s_mov_b32 s92, s80
  s_mov_b32 s93, s81
  s_mov_b32 s94, 524288
  s_mov_b32 s95, 0x20000
  s_cmp_eq_u32 s73, 2
  s_cbranch_scc1 L1
  v_lshrrev_b32 v28, 3, v0
  v_mul_lo_u32 v28, v28, s65
  v_and_b32_e64 v29, 7, v0
  v_lshl_add_u32 v28, v29, 4, v28
  s_lshl_b32 s44, s65, 3
  s_add_u32 m0, s22, 65536
  s_nop 0
  buffer_load_dwordx4 v28, s[60:63], s64 offen lds
  s_add_u32 m0, m0, 1024
  s_add_u32 s64, s64, s44
  buffer_load_dwordx4 v28, s[60:63], s64 offen lds
  s_add_u32 m0, m0, 1024
  s_add_u32 s64, s64, s44
  buffer_load_dwordx4 v28, s[60:63], s64 offen lds
  s_add_u32 m0, m0, 1024
  s_add_u32 s64, s64, s44
  buffer_load_dwordx4 v28, s[60:63], s64 offen lds
  s_cmp_eq_u32 s73, 3
  s_cbranch_scc1 L1
  s_add_u32 m0, m0, 1024
  s_add_u32 s64, s64, s44
  buffer_load_dwordx4 v28, s[60:63], s64 offen lds
  s_add_u32 m0, m0, 1024
  s_add_u32 s64, s64, s44
  buffer_load_dwordx4 v28, s[60:63], s64 offen lds
  s_add_u32 m0, m0, 1024
  s_add_u32 s64, s64, s44
  buffer_load_dwordx4 v28, s[60:63], s64 offen lds
  s_add_u32 m0, m0, 1024
  s_add_u32 s64, s64, s44
  buffer_load_dwordx4 v28, s[60:63], s64 offen lds
L1:
  s_mul_i32 s25, s18, 98304
  s_add_u32 s25, s25, s22
  s_lshl_b32 s27, s20, 7
  s_lshl_b32 s44, s14, 17
  s_add_u32 s27, s27, s44
  s_mul_i32 s28, s18, 229376
  s_add_u32 s28, s28, s22
  s_add_u32 s28, s28, 2621440
  s_mul_i32 s29, s18, 7168
  s_add_u32 s29, s29, s31
  s_add_u32 s29, s29, 6291456
  s_mul_i32 s30, s20, 229376
  s_mul_i32 s44, s14, 57344
  s_add_u32 s30, s30, s44
  s_add_u32 s30, s30, 6553600
  s_mov_b32 s32, 897988541
  s_mov_b32 s33, 1069066811
  v_add_u32 v2, 0x10000, v1
  v_add_u32 v3, 0x20000, v1
  v_lshlrev_b32 v6, 3, v0
  s_lshl_b32 s44, s14, 7
  s_add_u32 s44, s44, 156672
  v_lshlrev_b32 v21, 4, v18
  v_add_u32 v9, s44, v21
  v_lshlrev_b32 v21, 2, v19
  v_add_u32 v21, s44, v21
  v_accvgpr_write_b32 a240, v21
  v_and_b32 v21, 15, v0
  v_lshlrev_b32 v21, 6, v21
  v_lshl_add_u32 v21, v18, 5, v21
  v_bfe_u32 v22, v0, 4, 1
  v_mul_u32_u24 v22, 1088, v22
  s_mul_i32 s45, s14, 2304
  s_add_u32 s45, s45, 147456
  v_add3_u32 v21, v21, v22, s45
  v_accvgpr_write_b32 a241, v21
  s_mul_i32 s44, s14, 544
  v_lshlrev_b32 v21, 2, v0
  v_add_u32 v21, s44, v21
  v_accvgpr_write_b32 a243, v21
  v_add_u32 v21, 147456, v21
  v_accvgpr_write_b32 a242, v21
  v_and_b32_e64 v21, 3, v0
  v_bfe_u32 v22, v0, 2, 1
  v_lshl_add_u32 v21, v22, 3, v21
  v_bfe_u32 v22, v0, 3, 1
  v_lshl_add_u32 v21, v22, 2, v21
  v_lshlrev_b32_e64 v21, 2, v21
  v_bfe_u32 v22, v0, 4, 1
  v_mul_u32_u24 v22, 1088, v22
  v_add3_u32 v21, v21, v22, 64
  v_add_u32 v21, 960, v21
  v_add_u32_e64 v21, s45, v21
  v_accvgpr_write_b32 a244, v21
  s_add_u32 s44, s16, 2396160
  s_add_u32 s12, s4, s44
  s_addc_u32 s13, s5, 0
  s_add_u32 s58, s12, 14680064
  s_addc_u32 s59, s13, 0
  s_lshl_b32 s44, s21, 15
  s_add_u32 s34, s16, s44
  s_lshl_b32 s44, s21, 11
  s_add_u32 s35, s16, s44
  s_lshl_b32 s44, s19, 16
  s_add_u32 s36, s16, s44
  s_lshl_b32 s44, s20, 12
  s_add_u32 s37, s36, s44
  s_lshl_b32 s45, s14, 7
  s_add_u32 s37, s37, s45
  s_lshl_b32 s44, s19, 12
  s_add_u32 s38, s16, s44
  s_lshl_b32 s45, s14, 6
  s_add_u32 s38, s38, s45
  s_lshl_b32 s44, s20, 8
  s_add_u32 s38, s38, s44
  s_cmp_eq_u32 s15, 0
  s_cselect_b64 vcc, -1, 0
  v_bfe_u32 v20, v0, 2, 2
  v_bfe_u32 v21, v0, 4, 1
  v_and_b32 v22, 3, v0
  v_lshlrev_b32_e64 v21, 5, v21
  v_lshl_add_u32 v21, v22, 3, v21
  v_lshl_add_u32 v21, v20, 6, v21
  v_lshl_add_u32 v7, v18, 9, v21
  v_lshl_add_u32 v22, v18, 8, v21
  v_add_u32 v8, 98304, v7
  v_add_u32 v10, s31, v7
  s_lshl_b32 s44, s14, 12
  s_add_u32 s44, s44, 139264
  v_lshrrev_b32 v20, 4, v0
  v_xor_b32 v20, v20, v16
  v_lshlrev_b32 v20, 4, v20
  v_lshrrev_b32 v21, 3, v0
  v_lshl_add_u32 v20, v21, 7, v20
  v_add_u32 v26, s44, v20
  v_xor_b32 v27, 64, v26
  v_bfe_u32 v20, v0, 1, 3
  v_xor_b32 v20, v20, v18
  v_lshlrev_b32 v20, 4, v20
  v_lshl_add_u32 v20, v19, 7, v20
  v_add_u32 v28, s44, v20
  v_xor_b32 v29, 32, v28
  v_xor_b32_e64 v30, 64, v28
  v_xor_b32 v31, 0x60, v28
  v_mov_b32 v16, 0
  v_mov_b32 v17, 0
  v_mov_b32 v18, 0x3f803f80
  v_mov_b32 v20, 0
  v_mov_b32 v21, 0
  s_waitcnt vmcnt(8)
  s_cmp_eq_u32 s73, 1
  s_cbranch_scc1 L3
  s_waitcnt vmcnt(4)
  s_cmp_eq_u32 s73, 3
  s_cbranch_scc1 L3
  s_waitcnt vmcnt(0)
L3:
  s_barrier
  s_cmp_eq_u32 s51, 0
  s_cbranch_scc1 L4
  s_atomic_add s51, s[74:75], 0
L4:
  ds_read_b64_tr_b16 v[32:33], v7 offset:0
  ds_read_b64_tr_b16 v[34:35], v7 offset:256
  ds_read_b64_tr_b16 v[36:37], v7 offset:32768
  ds_read_b64_tr_b16 v[38:39], v7 offset:33024
  ds_read_b64_tr_b16 v[40:41], v7 offset:1024
  ds_read_b64_tr_b16 v[42:43], v7 offset:1280
  ds_read_b64_tr_b16 v[44:45], v7 offset:33792
  ds_read_b64_tr_b16 v[46:47], v7 offset:34048
  ds_write_b128 v26, v[128:131] offset:0
  ds_write_b128 v27, v[132:135] offset:1024
  ds_write_b128 v26, v[136:139] offset:2048
  ds_write_b128 v27, v[140:143] offset:3072
  ds_read_b128 v[128:131], v28
  ds_read_b128 v[132:135], v29
  ds_read_b128 v[136:139], v30
  ds_read_b128 v[140:143], v31
  s_waitcnt lgkmcnt(3)
  v_mfma_f32_32x32x16_bf16 v[64:79], v[128:131], v[32:35], 0
  ds_read_b64_tr_b16 v[48:49], v7 offset:2048
  ds_read_b64_tr_b16 v[50:51], v7 offset:2304
  s_add_u32 s46, s55, 1024
  s_add_u32 m0, s31, 8192
  s_nop 0
  buffer_load_dwordx4 v4, s[40:43], s46 offen lds
  ds_read_b64_tr_b16 v[96:97], v10 offset:0
  ds_read_b64_tr_b16 v[98:99], v10 offset:256
  ds_read_b64_tr_b16 v[100:101], v10 offset:1024
  ds_read_b64_tr_b16 v[102:103], v10 offset:1280
  v_dot2c_f32_bf16 v16, v128, v18
  v_dot2c_f32_bf16 v16, v129, v18
  v_dot2c_f32_bf16 v16, v130, v18
  v_mfma_f32_32x32x16_bf16 v[80:95], v[128:131], v[36:39], 0
  ds_read_b64_tr_b16 v[52:53], v7 offset:34816
  ds_read_b64_tr_b16 v[54:55], v7 offset:35072
  s_add_u32 s46, s55, 49152
  s_add_u32 m0, s31, 8192
  s_nop 0
  buffer_load_dwordx4 v4, s[40:43], s46 offen offset:1024 lds
  v_dot2c_f32_bf16 v16, v131, v18
  v_dot2c_f32_bf16 v17, v128, v128
  v_dot2c_f32_bf16 v17, v129, v129
  v_dot2c_f32_bf16 v17, v130, v130
  v_dot2c_f32_bf16 v17, v131, v131
  s_waitcnt lgkmcnt(10)
  v_dot2c_f32_bf16 v16, v132, v18
  v_dot2c_f32_bf16 v16, v133, v18
  v_mfma_f32_32x32x16_bf16 v[64:79], v[132:135], v[40:43], v[64:79]
  ds_read_b64_tr_b16 v[56:57], v7 offset:3072
  ds_read_b64_tr_b16 v[58:59], v7 offset:3328
  s_add_u32 s46, s55, 2048
  s_add_u32 m0, s31, 40960
  s_nop 0
  buffer_load_dwordx4 v4, s[40:43], s46 offen lds
  v_dot2c_f32_bf16 v16, v134, v18
  v_dot2c_f32_bf16 v16, v135, v18
  v_dot2c_f32_bf16 v17, v132, v132
  v_dot2c_f32_bf16 v17, v133, v133
  v_dot2c_f32_bf16 v17, v134, v134
  v_dot2c_f32_bf16 v17, v135, v135
  s_waitcnt lgkmcnt(4)
  v_dot2c_f32_bf16 v20, v96, v18
  v_mfma_f32_32x32x16_bf16 v[80:95], v[132:135], v[44:47], v[80:95]
  ds_read_b64_tr_b16 v[60:61], v7 offset:35840
  ds_read_b64_tr_b16 v[62:63], v7 offset:36096
  s_add_u32 s46, s55, 50176
  s_add_u32 m0, s31, 40960
  s_nop 0
  buffer_load_dwordx4 v4, s[40:43], s46 offen offset:1024 lds
  v_dot2c_f32_bf16 v20, v97, v18
  v_dot2c_f32_bf16 v20, v98, v18
  v_dot2c_f32_bf16 v20, v99, v18
  v_dot2c_f32_bf16 v20, v100, v18
  v_dot2c_f32_bf16 v20, v101, v18
  v_dot2c_f32_bf16 v20, v102, v18
  v_dot2c_f32_bf16 v20, v103, v18
  v_mfma_f32_32x32x16_bf16 v[64:79], v[136:139], v[48:51], v[64:79]
  ds_read_b64_tr_b16 v[32:33], v7 offset:4096
  ds_read_b64_tr_b16 v[34:35], v7 offset:4352
  s_add_u32 s52, s26, 2
  s_and_b32 s52, s52, 7
  s_lshl_b32 s52, s52, 7
  s_add_u32 s52, s52, s50
  buffer_load_dwordx4 v[160:163], v5, s[8:11], s52 offen
  v_dot2c_f32_bf16 v16, v136, v18
  v_dot2c_f32_bf16 v16, v137, v18
  v_dot2c_f32_bf16 v16, v138, v18
  v_dot2c_f32_bf16 v16, v139, v18
  v_dot2c_f32_bf16 v17, v136, v136
  v_dot2c_f32_bf16 v17, v137, v137
  v_dot2c_f32_bf16 v17, v138, v138
  v_dot2c_f32_bf16 v17, v139, v139
  s_waitcnt lgkmcnt(6)
  v_mfma_f32_32x32x16_bf16 v[80:95], v[136:139], v[52:55], v[80:95]
  ds_read_b64_tr_b16 v[36:37], v7 offset:36864
  ds_read_b64_tr_b16 v[38:39], v7 offset:37120
  s_add_u32 s52, s52, 0x2000
  buffer_load_dwordx4 v[164:167], v5, s[8:11], s52 offen
  ds_write_b128 v26, v[144:147] offset:0
  ds_write_b128 v27, v[148:151] offset:1024
  ds_write_b128 v26, v[152:155] offset:2048
  ds_write_b128 v27, v[156:159] offset:3072
  ds_read_b128 v[144:147], v28
  ds_read_b128 v[148:151], v29
  ds_read_b128 v[152:155], v30
  s_waitcnt lgkmcnt(13)
  v_mfma_f32_32x32x16_bf16 v[64:79], v[140:143], v[56:59], v[64:79]
  ds_read_b64_tr_b16 v[40:41], v7 offset:5120
  ds_read_b64_tr_b16 v[42:43], v7 offset:5376
  s_add_u32 s52, s52, 0x2000
  buffer_load_dwordx4 v[168:171], v5, s[8:11], s52 offen
  ds_read_b128 v[156:159], v31
  v_dot2c_f32_bf16 v16, v140, v18
  v_dot2c_f32_bf16 v16, v141, v18
  v_dot2c_f32_bf16 v16, v142, v18
  v_dot2c_f32_bf16 v16, v143, v18
  v_dot2c_f32_bf16 v17, v140, v140
  v_dot2c_f32_bf16 v17, v141, v141
  s_waitcnt lgkmcnt(14)
  v_mfma_f32_32x32x16_bf16 v[80:95], v[140:143], v[60:63], v[80:95]
  ds_read_b64_tr_b16 v[44:45], v7 offset:37888
  ds_read_b64_tr_b16 v[46:47], v7 offset:38144
  s_add_u32 s52, s52, 0x2000
  buffer_load_dwordx4 v[172:175], v5, s[8:11], s52 offen
  v_dot2c_f32_bf16 v17, v142, v142
  v_dot2c_f32_bf16 v17, v143, v143
  s_waitcnt lgkmcnt(7)
  v_mfma_f32_32x32x16_bf16 v[64:79], v[144:147], v[32:35], v[64:79]
  ds_read_b64_tr_b16 v[48:49], v7 offset:6144
  ds_read_b64_tr_b16 v[50:51], v7 offset:6400
  s_add_u32 s52, s26, 3
  s_and_b32 s52, s52, 7
  s_lshl_b32 s52, s52, 7
  s_add_u32 s52, s52, s50
  buffer_load_dwordx4 v[176:179], v5, s[8:11], s52 offen
  ds_read_b64_tr_b16 v[96:97], v10 offset:32768
  ds_read_b64_tr_b16 v[98:99], v10 offset:33024
  ds_read_b64_tr_b16 v[100:101], v10 offset:33792
  ds_read_b64_tr_b16 v[102:103], v10 offset:34048
  v_dot2c_f32_bf16 v16, v144, v18
  v_dot2c_f32_bf16 v16, v145, v18
  v_dot2c_f32_bf16 v16, v146, v18
  v_mfma_f32_32x32x16_bf16 v[80:95], v[144:147], v[36:39], v[80:95]
  ds_read_b64_tr_b16 v[52:53], v7 offset:38912
  ds_read_b64_tr_b16 v[54:55], v7 offset:39168
  s_add_u32 s52, s52, 0x2000
  buffer_load_dwordx4 v[180:183], v5, s[8:11], s52 offen
  v_dot2c_f32_bf16 v16, v147, v18
  v_dot2c_f32_bf16 v17, v144, v144
  v_dot2c_f32_bf16 v17, v145, v145
  v_dot2c_f32_bf16 v17, v146, v146
  v_dot2c_f32_bf16 v17, v147, v147
  s_waitcnt lgkmcnt(14)
  v_dot2c_f32_bf16 v16, v148, v18
  v_dot2c_f32_bf16 v16, v149, v18
  s_waitcnt lgkmcnt(11)
  v_mfma_f32_32x32x16_bf16 v[64:79], v[148:151], v[40:43], v[64:79]
  ds_read_b64_tr_b16 v[56:57], v7 offset:7168
  ds_read_b64_tr_b16 v[58:59], v7 offset:7424
  s_add_u32 s52, s52, 0x2000
  buffer_load_dwordx4 v[184:187], v5, s[8:11], s52 offen
  v_dot2c_f32_bf16 v16, v150, v18
  v_dot2c_f32_bf16 v16, v151, v18
  v_dot2c_f32_bf16 v17, v148, v148
  v_dot2c_f32_bf16 v17, v149, v149
  v_dot2c_f32_bf16 v17, v150, v150
  v_dot2c_f32_bf16 v17, v151, v151
  s_waitcnt lgkmcnt(4)
  v_dot2c_f32_bf16 v21, v96, v18
  v_mfma_f32_32x32x16_bf16 v[80:95], v[148:151], v[44:47], v[80:95]
  ds_read_b64_tr_b16 v[60:61], v7 offset:39936
  ds_read_b64_tr_b16 v[62:63], v7 offset:40192
  s_add_u32 s52, s52, 0x2000
  buffer_load_dwordx4 v[188:191], v5, s[8:11], s52 offen
  v_dot2c_f32_bf16 v21, v97, v18
  v_dot2c_f32_bf16 v21, v98, v18
  v_dot2c_f32_bf16 v21, v99, v18
  v_dot2c_f32_bf16 v21, v100, v18
  v_dot2c_f32_bf16 v21, v101, v18
  v_dot2c_f32_bf16 v21, v102, v18
  v_dot2c_f32_bf16 v21, v103, v18
  v_mfma_f32_32x32x16_bf16 v[64:79], v[152:155], v[48:51], v[64:79]
  s_add_u32 s46, s56, 1024
  s_add_u32 m0, s31, 16384
  s_nop 0
  buffer_load_dwordx4 v4, s[40:43], s46 offen lds
  v_dot2c_f32_bf16 v16, v152, v18
  v_dot2c_f32_bf16 v16, v153, v18
  v_dot2c_f32_bf16 v16, v154, v18
  v_dot2c_f32_bf16 v16, v155, v18
  v_dot2c_f32_bf16 v17, v152, v152
  v_dot2c_f32_bf16 v17, v153, v153
  v_dot2c_f32_bf16 v17, v154, v154
  v_dot2c_f32_bf16 v17, v155, v155
  s_waitcnt vmcnt(9)
  s_barrier
  s_add_u32 s46, s56, 49152
  s_add_u32 m0, s31, 16384
  s_nop 0
  buffer_load_dwordx4 v4, s[40:43], s46 offen offset:1024 lds
  s_waitcnt vmcnt(6)
  ds_write_b128 v26, v[160:163] offset:0
  ds_write_b128 v27, v[164:167] offset:1024
  ds_write_b128 v26, v[168:171] offset:2048
  ds_write_b128 v27, v[172:175] offset:3072
  ds_read_b128 v[160:163], v28
  ds_read_b128 v[164:167], v29
  ds_read_b128 v[168:171], v30
  s_waitcnt lgkmcnt(11)
  v_mfma_f32_32x32x16_bf16 v[80:95], v[152:155], v[52:55], v[80:95]
  ds_read_b64_tr_b16 v[32:33], v7 offset:8192
  ds_read_b64_tr_b16 v[34:35], v7 offset:8448
  ds_read_b64_tr_b16 v[36:37], v7 offset:40960
  ds_read_b64_tr_b16 v[38:39], v7 offset:41216
  s_add_u32 s46, s56, 2048
  s_add_u32 m0, s31, 49152
  s_nop 0
  buffer_load_dwordx4 v4, s[40:43], s46 offen lds
  ds_read_b128 v[172:175], v31
  v_dot2c_f32_bf16 v16, v156, v18
  v_dot2c_f32_bf16 v16, v157, v18
  v_dot2c_f32_bf16 v16, v158, v18
  v_dot2c_f32_bf16 v16, v159, v18
  v_dot2c_f32_bf16 v17, v156, v156
  v_dot2c_f32_bf16 v17, v157, v157
  s_waitcnt lgkmcnt(14)
  v_mfma_f32_32x32x16_bf16 v[64:79], v[156:159], v[56:59], v[64:79]
  ds_read_b64_tr_b16 v[40:41], v7 offset:9216
  ds_read_b64_tr_b16 v[42:43], v7 offset:9472
  s_add_u32 s46, s56, 50176
  s_add_u32 m0, s31, 49152
  s_nop 0
  buffer_load_dwordx4 v4, s[40:43], s46 offen offset:1024 lds
  v_dot2c_f32_bf16 v17, v158, v158
  v_dot2c_f32_bf16 v17, v159, v159
  s_waitcnt lgkmcnt(14)
  v_mfma_f32_32x32x16_bf16 v[80:95], v[156:159], v[60:63], v[80:95]
  ds_read_b64_tr_b16 v[44:45], v7 offset:41984
  ds_read_b64_tr_b16 v[46:47], v7 offset:42240
  s_add_u32 s52, s26, 4
  s_and_b32 s52, s52, 7
  s_lshl_b32 s52, s52, 7
  s_add_u32 s52, s52, s50
  buffer_load_dwordx4 v[192:195], v5, s[8:11], s52 offen
  s_waitcnt lgkmcnt(11)
  s_waitcnt lgkmcnt(7)
  v_mfma_f32_32x32x16_bf16 v[64:79], v[160:163], v[32:35], v[64:79]
  ds_read_b64_tr_b16 v[48:49], v7 offset:10240
  ds_read_b64_tr_b16 v[50:51], v7 offset:10496
  s_add_u32 s52, s52, 0x2000
  buffer_load_dwordx4 v[196:199], v5, s[8:11], s52 offen
  ds_read_b64_tr_b16 v[96:97], v10 offset:8192
  ds_read_b64_tr_b16 v[98:99], v10 offset:8448
  ds_read_b64_tr_b16 v[100:101], v10 offset:9216
  ds_read_b64_tr_b16 v[102:103], v10 offset:9472
  v_dot2c_f32_bf16 v16, v160, v18
  v_dot2c_f32_bf16 v16, v161, v18
  v_dot2c_f32_bf16 v16, v162, v18
  s_waitcnt lgkmcnt(11)
  v_mfma_f32_32x32x16_bf16 v[80:95], v[160:163], v[36:39], v[80:95]
  ds_read_b64_tr_b16 v[52:53], v7 offset:43008
  ds_read_b64_tr_b16 v[54:55], v7 offset:43264
  s_add_u32 s52, s52, 0x2000
  buffer_load_dwordx4 v[200:203], v5, s[8:11], s52 offen
  v_dot2c_f32_bf16 v16, v163, v18
  v_dot2c_f32_bf16 v17, v160, v160
  v_dot2c_f32_bf16 v17, v161, v161
  v_dot2c_f32_bf16 v17, v162, v162
  v_dot2c_f32_bf16 v17, v163, v163
  v_dot2c_f32_bf16 v16, v164, v18
  v_dot2c_f32_bf16 v16, v165, v18
  s_waitcnt lgkmcnt(10)
  v_mfma_f32_32x32x16_bf16 v[64:79], v[164:167], v[40:43], v[64:79]
  ds_read_b64_tr_b16 v[56:57], v7 offset:11264
  ds_read_b64_tr_b16 v[58:59], v7 offset:11520
  s_add_u32 s52, s52, 0x2000
  buffer_load_dwordx4 v[204:207], v5, s[8:11], s52 offen
  v_dot2c_f32_bf16 v16, v166, v18
  v_dot2c_f32_bf16 v16, v167, v18
  v_dot2c_f32_bf16 v17, v164, v164
  v_dot2c_f32_bf16 v17, v165, v165
  v_dot2c_f32_bf16 v17, v166, v166
  v_dot2c_f32_bf16 v17, v167, v167
  s_waitcnt lgkmcnt(4)
  v_dot2c_f32_bf16 v20, v96, v18
  v_mfma_f32_32x32x16_bf16 v[80:95], v[164:167], v[44:47], v[80:95]
  ds_read_b64_tr_b16 v[60:61], v7 offset:44032
  ds_read_b64_tr_b16 v[62:63], v7 offset:44288
  s_add_u32 s52, s26, 5
  s_and_b32 s52, s52, 7
  s_lshl_b32 s52, s52, 7
  s_add_u32 s52, s52, s50
  buffer_load_dwordx4 v[208:211], v5, s[8:11], s52 offen
  v_dot2c_f32_bf16 v20, v97, v18
  v_dot2c_f32_bf16 v20, v98, v18
  v_dot2c_f32_bf16 v20, v99, v18
  v_dot2c_f32_bf16 v20, v100, v18
  v_dot2c_f32_bf16 v20, v101, v18
  v_dot2c_f32_bf16 v20, v102, v18
  v_dot2c_f32_bf16 v20, v103, v18
  v_mfma_f32_32x32x16_bf16 v[64:79], v[168:171], v[48:51], v[64:79]
  ds_read_b64_tr_b16 v[32:33], v7 offset:12288
  ds_read_b64_tr_b16 v[34:35], v7 offset:12544
  s_add_u32 s52, s52, 0x2000
  buffer_load_dwordx4 v[212:215], v5, s[8:11], s52 offen
  v_dot2c_f32_bf16 v16, v168, v18
  v_dot2c_f32_bf16 v16, v169, v18
  v_dot2c_f32_bf16 v16, v170, v18
  v_dot2c_f32_bf16 v16, v171, v18
  v_dot2c_f32_bf16 v17, v168, v168
  v_dot2c_f32_bf16 v17, v169, v169
  v_dot2c_f32_bf16 v17, v170, v170
  v_dot2c_f32_bf16 v17, v171, v171
  s_waitcnt lgkmcnt(6)
  v_mfma_f32_32x32x16_bf16 v[80:95], v[168:171], v[52:55], v[80:95]
  ds_read_b64_tr_b16 v[36:37], v7 offset:45056
  ds_read_b64_tr_b16 v[38:39], v7 offset:45312
  s_add_u32 s52, s52, 0x2000
  buffer_load_dwordx4 v[216:219], v5, s[8:11], s52 offen
  s_waitcnt vmcnt(11)
  ds_write_b128 v26, v[176:179] offset:0
  ds_write_b128 v27, v[180:183] offset:1024
  ds_write_b128 v26, v[184:187] offset:2048
  ds_write_b128 v27, v[188:191] offset:3072
  ds_read_b128 v[176:179], v28
  ds_read_b128 v[180:183], v29
  ds_read_b128 v[184:187], v30
  s_waitcnt lgkmcnt(13)
  v_mfma_f32_32x32x16_bf16 v[64:79], v[172:175], v[56:59], v[64:79]
  ds_read_b64_tr_b16 v[40:41], v7 offset:13312
  ds_read_b64_tr_b16 v[42:43], v7 offset:13568
  s_add_u32 s52, s52, 0x2000
  buffer_load_dwordx4 v[220:223], v5, s[8:11], s52 offen
  ds_read_b128 v[188:191], v31
  v_dot2c_f32_bf16 v16, v172, v18
  v_dot2c_f32_bf16 v16, v173, v18
  v_dot2c_f32_bf16 v16, v174, v18
  v_dot2c_f32_bf16 v16, v175, v18
  v_dot2c_f32_bf16 v17, v172, v172
  v_dot2c_f32_bf16 v17, v173, v173
  s_waitcnt lgkmcnt(14)
  v_mfma_f32_32x32x16_bf16 v[80:95], v[172:175], v[60:63], v[80:95]
  ds_read_b64_tr_b16 v[44:45], v7 offset:46080
  ds_read_b64_tr_b16 v[46:47], v7 offset:46336
  s_add_u32 s46, s57, 1024
  s_add_u32 m0, s31, 24576
  s_nop 0
  buffer_load_dwordx4 v4, s[40:43], s46 offen lds
  v_dot2c_f32_bf16 v17, v174, v174
  v_dot2c_f32_bf16 v17, v175, v175
  s_waitcnt lgkmcnt(7)
  v_mfma_f32_32x32x16_bf16 v[64:79], v[176:179], v[32:35], v[64:79]
  ds_read_b64_tr_b16 v[48:49], v7 offset:14336
  ds_read_b64_tr_b16 v[50:51], v7 offset:14592
  s_add_u32 s46, s57, 49152
  s_add_u32 m0, s31, 24576
  s_nop 0
  buffer_load_dwordx4 v4, s[40:43], s46 offen offset:1024 lds
  ds_read_b64_tr_b16 v[96:97], v10 offset:40960
  ds_read_b64_tr_b16 v[98:99], v10 offset:41216
  ds_read_b64_tr_b16 v[100:101], v10 offset:41984
  ds_read_b64_tr_b16 v[102:103], v10 offset:42240
  v_dot2c_f32_bf16 v16, v176, v18
  v_dot2c_f32_bf16 v16, v177, v18
  v_dot2c_f32_bf16 v16, v178, v18
  v_mfma_f32_32x32x16_bf16 v[80:95], v[176:179], v[36:39], v[80:95]
  ds_read_b64_tr_b16 v[52:53], v7 offset:47104
  ds_read_b64_tr_b16 v[54:55], v7 offset:47360
  s_add_u32 s46, s57, 2048
  s_add_u32 m0, s31, 57344
  s_nop 0
  buffer_load_dwordx4 v4, s[40:43], s46 offen lds
  v_dot2c_f32_bf16 v16, v179, v18
  v_dot2c_f32_bf16 v17, v176, v176
  v_dot2c_f32_bf16 v17, v177, v177
  v_dot2c_f32_bf16 v17, v178, v178
  v_dot2c_f32_bf16 v17, v179, v179
  s_waitcnt lgkmcnt(14)
  v_dot2c_f32_bf16 v16, v180, v18
  v_dot2c_f32_bf16 v16, v181, v18
  s_waitcnt lgkmcnt(11)
  v_mfma_f32_32x32x16_bf16 v[64:79], v[180:183], v[40:43], v[64:79]
  ds_read_b64_tr_b16 v[56:57], v7 offset:15360
  ds_read_b64_tr_b16 v[58:59], v7 offset:15616
  s_add_u32 s46, s57, 50176
  s_add_u32 m0, s31, 57344
  s_nop 0
  buffer_load_dwordx4 v4, s[40:43], s46 offen offset:1024 lds
  v_dot2c_f32_bf16 v16, v182, v18
  v_dot2c_f32_bf16 v16, v183, v18
  v_dot2c_f32_bf16 v17, v180, v180
  v_dot2c_f32_bf16 v17, v181, v181
  v_dot2c_f32_bf16 v17, v182, v182
  v_dot2c_f32_bf16 v17, v183, v183
  s_waitcnt lgkmcnt(4)
  v_dot2c_f32_bf16 v21, v96, v18
  v_mfma_f32_32x32x16_bf16 v[80:95], v[180:183], v[44:47], v[80:95]
  ds_read_b64_tr_b16 v[60:61], v7 offset:48128
  ds_read_b64_tr_b16 v[62:63], v7 offset:48384
  s_add_u32 s52, s26, 6
  s_and_b32 s52, s52, 7
  s_lshl_b32 s52, s52, 7
  s_add_u32 s52, s52, s50
  buffer_load_dwordx4 v[224:227], v5, s[8:11], s52 offen
  v_dot2c_f32_bf16 v21, v97, v18
  v_dot2c_f32_bf16 v21, v98, v18
  v_dot2c_f32_bf16 v21, v99, v18
  v_dot2c_f32_bf16 v21, v100, v18
  v_dot2c_f32_bf16 v21, v101, v18
  v_dot2c_f32_bf16 v21, v102, v18
  v_dot2c_f32_bf16 v21, v103, v18
  v_mfma_f32_32x32x16_bf16 v[64:79], v[184:187], v[48:51], v[64:79]
  s_add_u32 s52, s52, 0x2000
  buffer_load_dwordx4 v[228:231], v5, s[8:11], s52 offen
  v_dot2c_f32_bf16 v16, v184, v18
  v_dot2c_f32_bf16 v16, v185, v18
  v_dot2c_f32_bf16 v16, v186, v18
  v_dot2c_f32_bf16 v16, v187, v18
  v_dot2c_f32_bf16 v17, v184, v184
  v_dot2c_f32_bf16 v17, v185, v185
  v_dot2c_f32_bf16 v17, v186, v186
  v_dot2c_f32_bf16 v17, v187, v187
  s_waitcnt vmcnt(14)
  s_barrier
  s_add_u32 s52, s52, 0x2000
  buffer_load_dwordx4 v[232:235], v5, s[8:11], s52 offen
  s_waitcnt vmcnt(11)
  ds_write_b128 v26, v[192:195] offset:0
  ds_write_b128 v27, v[196:199] offset:1024
  ds_write_b128 v26, v[200:203] offset:2048
  ds_write_b128 v27, v[204:207] offset:3072
  ds_read_b128 v[192:195], v28
  ds_read_b128 v[196:199], v29
  ds_read_b128 v[200:203], v30
  s_waitcnt lgkmcnt(11)
  v_mfma_f32_32x32x16_bf16 v[80:95], v[184:187], v[52:55], v[80:95]
  ds_read_b64_tr_b16 v[32:33], v7 offset:16384
  ds_read_b64_tr_b16 v[34:35], v7 offset:16640
  ds_read_b64_tr_b16 v[36:37], v7 offset:49152
  ds_read_b64_tr_b16 v[38:39], v7 offset:49408
  s_add_u32 s52, s52, 0x2000
  buffer_load_dwordx4 v[236:239], v5, s[8:11], s52 offen
  ds_read_b128 v[204:207], v31
  v_dot2c_f32_bf16 v16, v188, v18
  v_dot2c_f32_bf16 v16, v189, v18
  v_dot2c_f32_bf16 v16, v190, v18
  v_dot2c_f32_bf16 v16, v191, v18
  v_dot2c_f32_bf16 v17, v188, v188
  v_dot2c_f32_bf16 v17, v189, v189
  s_waitcnt lgkmcnt(14)
  v_mfma_f32_32x32x16_bf16 v[64:79], v[188:191], v[56:59], v[64:79]
  ds_read_b64_tr_b16 v[40:41], v7 offset:17408
  ds_read_b64_tr_b16 v[42:43], v7 offset:17664
  s_add_u32 s52, s26, 7
  s_and_b32 s52, s52, 7
  s_lshl_b32 s52, s52, 7
  s_add_u32 s52, s52, s50
  buffer_load_dwordx4 v[240:243], v5, s[8:11], s52 offen
  v_dot2c_f32_bf16 v17, v190, v190
  v_dot2c_f32_bf16 v17, v191, v191
  s_waitcnt lgkmcnt(14)
  v_mfma_f32_32x32x16_bf16 v[80:95], v[188:191], v[60:63], v[80:95]
  ds_read_b64_tr_b16 v[44:45], v7 offset:50176
  ds_read_b64_tr_b16 v[46:47], v7 offset:50432
  s_add_u32 s52, s52, 0x2000
  buffer_load_dwordx4 v[244:247], v5, s[8:11], s52 offen
  s_waitcnt lgkmcnt(11)
  s_waitcnt lgkmcnt(7)
  v_mfma_f32_32x32x16_bf16 v[64:79], v[192:195], v[32:35], v[64:79]
  ds_read_b64_tr_b16 v[48:49], v7 offset:18432
  ds_read_b64_tr_b16 v[50:51], v7 offset:18688
  s_add_u32 s52, s52, 0x2000
  buffer_load_dwordx4 v[248:251], v5, s[8:11], s52 offen
  ds_read_b64_tr_b16 v[96:97], v10 offset:16384
  ds_read_b64_tr_b16 v[98:99], v10 offset:16640
  ds_read_b64_tr_b16 v[100:101], v10 offset:17408
  ds_read_b64_tr_b16 v[102:103], v10 offset:17664
  v_dot2c_f32_bf16 v16, v192, v18
  v_dot2c_f32_bf16 v16, v193, v18
  v_dot2c_f32_bf16 v16, v194, v18
  s_waitcnt lgkmcnt(11)
  v_mfma_f32_32x32x16_bf16 v[80:95], v[192:195], v[36:39], v[80:95]
  ds_read_b64_tr_b16 v[52:53], v7 offset:51200
  ds_read_b64_tr_b16 v[54:55], v7 offset:51456
  s_add_u32 s52, s52, 0x2000
  buffer_load_dwordx4 v[252:255], v5, s[8:11], s52 offen
  v_dot2c_f32_bf16 v16, v195, v18
  v_dot2c_f32_bf16 v17, v192, v192
  v_dot2c_f32_bf16 v17, v193, v193
  v_dot2c_f32_bf16 v17, v194, v194
  v_dot2c_f32_bf16 v17, v195, v195
  v_dot2c_f32_bf16 v16, v196, v18
  v_dot2c_f32_bf16 v16, v197, v18
  s_waitcnt lgkmcnt(10)
  v_mfma_f32_32x32x16_bf16 v[64:79], v[196:199], v[40:43], v[64:79]
  ds_read_b64_tr_b16 v[56:57], v7 offset:19456
  ds_read_b64_tr_b16 v[58:59], v7 offset:19712
  s_add_u32 s46, s54, 0
  s_add_u32 m0, s31, 98304
  s_nop 0
  buffer_load_dwordx4 v4, s[40:43], s46 offen lds
  v_dot2c_f32_bf16 v16, v198, v18
  v_dot2c_f32_bf16 v16, v199, v18
  v_dot2c_f32_bf16 v17, v196, v196
  v_dot2c_f32_bf16 v17, v197, v197
  v_dot2c_f32_bf16 v17, v198, v198
  v_dot2c_f32_bf16 v17, v199, v199
  s_waitcnt lgkmcnt(4)
  v_dot2c_f32_bf16 v20, v96, v18
  v_mfma_f32_32x32x16_bf16 v[80:95], v[196:199], v[44:47], v[80:95]
  ds_read_b64_tr_b16 v[60:61], v7 offset:52224
  ds_read_b64_tr_b16 v[62:63], v7 offset:52480
  s_add_u32 s46, s54, 48128
  s_add_u32 m0, s31, 98304
  s_nop 0
  buffer_load_dwordx4 v4, s[40:43], s46 offen offset:1024 lds
  v_dot2c_f32_bf16 v20, v97, v18
  v_dot2c_f32_bf16 v20, v98, v18
  v_dot2c_f32_bf16 v20, v99, v18
  v_dot2c_f32_bf16 v20, v100, v18
  v_dot2c_f32_bf16 v20, v101, v18
  v_dot2c_f32_bf16 v20, v102, v18
  v_dot2c_f32_bf16 v20, v103, v18
  v_mfma_f32_32x32x16_bf16 v[64:79], v[200:203], v[48:51], v[64:79]
  ds_read_b64_tr_b16 v[32:33], v7 offset:20480
  ds_read_b64_tr_b16 v[34:35], v7 offset:20736
  s_add_u32 s46, s55, 0
  s_add_u32 m0, s31, 106496
  s_nop 0
  buffer_load_dwordx4 v4, s[40:43], s46 offen lds
  v_dot2c_f32_bf16 v16, v200, v18
  v_dot2c_f32_bf16 v16, v201, v18
  v_dot2c_f32_bf16 v16, v202, v18
  v_dot2c_f32_bf16 v16, v203, v18
  v_dot2c_f32_bf16 v17, v200, v200
  v_dot2c_f32_bf16 v17, v201, v201
  v_dot2c_f32_bf16 v17, v202, v202
  v_dot2c_f32_bf16 v17, v203, v203
  s_waitcnt lgkmcnt(6)
  v_mfma_f32_32x32x16_bf16 v[80:95], v[200:203], v[52:55], v[80:95]
  ds_read_b64_tr_b16 v[36:37], v7 offset:53248
  ds_read_b64_tr_b16 v[38:39], v7 offset:53504
  s_add_u32 s46, s55, 48128
  s_add_u32 m0, s31, 106496
  s_nop 0
  buffer_load_dwordx4 v4, s[40:43], s46 offen offset:1024 lds
  s_waitcnt vmcnt(16)
  ds_write_b128 v26, v[208:211] offset:0
  ds_write_b128 v27, v[212:215] offset:1024
  ds_write_b128 v26, v[216:219] offset:2048
  ds_write_b128 v27, v[220:223] offset:3072
  ds_read_b128 v[208:211], v28
  ds_read_b128 v[212:215], v29
  ds_read_b128 v[216:219], v30
  s_waitcnt lgkmcnt(13)
  v_mfma_f32_32x32x16_bf16 v[64:79], v[204:207], v[56:59], v[64:79]
  ds_read_b64_tr_b16 v[40:41], v7 offset:21504
  ds_read_b64_tr_b16 v[42:43], v7 offset:21760
  s_add_u32 s46, s56, 0
  s_add_u32 m0, s31, 114688
  s_nop 0
  buffer_load_dwordx4 v4, s[40:43], s46 offen lds
  ds_read_b128 v[220:223], v31
  v_dot2c_f32_bf16 v16, v204, v18
  v_dot2c_f32_bf16 v16, v205, v18
  v_dot2c_f32_bf16 v16, v206, v18
  v_dot2c_f32_bf16 v16, v207, v18
  v_dot2c_f32_bf16 v17, v204, v204
  v_dot2c_f32_bf16 v17, v205, v205
  s_waitcnt lgkmcnt(14)
  v_mfma_f32_32x32x16_bf16 v[80:95], v[204:207], v[60:63], v[80:95]
  ds_read_b64_tr_b16 v[44:45], v7 offset:54272
  ds_read_b64_tr_b16 v[46:47], v7 offset:54528
  s_add_u32 s46, s56, 48128
  s_add_u32 m0, s31, 114688
  s_nop 0
  buffer_load_dwordx4 v4, s[40:43], s46 offen offset:1024 lds
  v_dot2c_f32_bf16 v17, v206, v206
  v_dot2c_f32_bf16 v17, v207, v207
  s_waitcnt lgkmcnt(7)
  v_mfma_f32_32x32x16_bf16 v[64:79], v[208:211], v[32:35], v[64:79]
  ds_read_b64_tr_b16 v[48:49], v7 offset:22528
  ds_read_b64_tr_b16 v[50:51], v7 offset:22784
  s_add_u32 s46, s57, 0
  s_add_u32 m0, s31, 122880
  s_nop 0
  buffer_load_dwordx4 v4, s[40:43], s46 offen lds
  ds_read_b64_tr_b16 v[96:97], v10 offset:49152
  ds_read_b64_tr_b16 v[98:99], v10 offset:49408
  ds_read_b64_tr_b16 v[100:101], v10 offset:50176
  ds_read_b64_tr_b16 v[102:103], v10 offset:50432
  v_dot2c_f32_bf16 v16, v208, v18
  v_dot2c_f32_bf16 v16, v209, v18
  v_dot2c_f32_bf16 v16, v210, v18
  v_mfma_f32_32x32x16_bf16 v[80:95], v[208:211], v[36:39], v[80:95]
  ds_read_b64_tr_b16 v[52:53], v7 offset:55296
  ds_read_b64_tr_b16 v[54:55], v7 offset:55552
  s_add_u32 s46, s57, 48128
  s_add_u32 m0, s31, 122880
  s_nop 0
  buffer_load_dwordx4 v4, s[40:43], s46 offen offset:1024 lds
  v_dot2c_f32_bf16 v16, v211, v18
  v_dot2c_f32_bf16 v17, v208, v208
  v_dot2c_f32_bf16 v17, v209, v209
  v_dot2c_f32_bf16 v17, v210, v210
  v_dot2c_f32_bf16 v17, v211, v211
  s_waitcnt lgkmcnt(14)
  v_dot2c_f32_bf16 v16, v212, v18
  v_dot2c_f32_bf16 v16, v213, v18
  s_waitcnt lgkmcnt(11)
  v_mfma_f32_32x32x16_bf16 v[64:79], v[212:215], v[40:43], v[64:79]
  ds_read_b64_tr_b16 v[56:57], v7 offset:23552
  ds_read_b64_tr_b16 v[58:59], v7 offset:23808
  v_dot2c_f32_bf16 v16, v214, v18
  v_dot2c_f32_bf16 v16, v215, v18
  v_dot2c_f32_bf16 v17, v212, v212
  v_dot2c_f32_bf16 v17, v213, v213
  v_dot2c_f32_bf16 v17, v214, v214
  v_dot2c_f32_bf16 v17, v215, v215
  s_waitcnt lgkmcnt(4)
  v_dot2c_f32_bf16 v21, v96, v18
  v_mfma_f32_32x32x16_bf16 v[80:95], v[212:215], v[44:47], v[80:95]
  ds_read_b64_tr_b16 v[60:61], v7 offset:56320
  ds_read_b64_tr_b16 v[62:63], v7 offset:56576
  v_dot2c_f32_bf16 v21, v97, v18
  v_dot2c_f32_bf16 v21, v98, v18
  v_dot2c_f32_bf16 v21, v99, v18
  v_dot2c_f32_bf16 v21, v100, v18
  v_dot2c_f32_bf16 v21, v101, v18
  v_dot2c_f32_bf16 v21, v102, v18
  v_dot2c_f32_bf16 v21, v103, v18
  v_mfma_f32_32x32x16_bf16 v[64:79], v[216:219], v[48:51], v[64:79]
  v_dot2c_f32_bf16 v16, v216, v18
  v_dot2c_f32_bf16 v16, v217, v18
  v_dot2c_f32_bf16 v16, v218, v18
  v_dot2c_f32_bf16 v16, v219, v18
  v_dot2c_f32_bf16 v17, v216, v216
  v_dot2c_f32_bf16 v17, v217, v217
  v_dot2c_f32_bf16 v17, v218, v218
  v_dot2c_f32_bf16 v17, v219, v219
  s_waitcnt vmcnt(16)
  s_barrier
  s_waitcnt vmcnt(12)
  ds_write_b128 v26, v[224:227] offset:0
  ds_write_b128 v27, v[228:231] offset:1024
  ds_write_b128 v26, v[232:235] offset:2048
  ds_write_b128 v27, v[236:239] offset:3072
  ds_read_b128 v[224:227], v28
  ds_read_b128 v[228:231], v29
  ds_read_b128 v[232:235], v30
  s_waitcnt lgkmcnt(11)
  v_mfma_f32_32x32x16_bf16 v[80:95], v[216:219], v[52:55], v[80:95]
  ds_read_b64_tr_b16 v[32:33], v7 offset:24576
  ds_read_b64_tr_b16 v[34:35], v7 offset:24832
  ds_read_b64_tr_b16 v[36:37], v7 offset:57344
  ds_read_b64_tr_b16 v[38:39], v7 offset:57600
  ds_read_b128 v[236:239], v31
  v_dot2c_f32_bf16 v16, v220, v18
  v_dot2c_f32_bf16 v16, v221, v18
  v_dot2c_f32_bf16 v16, v222, v18
  v_dot2c_f32_bf16 v16, v223, v18
  v_dot2c_f32_bf16 v17, v220, v220
  v_dot2c_f32_bf16 v17, v221, v221
  s_waitcnt lgkmcnt(14)
  v_mfma_f32_32x32x16_bf16 v[64:79], v[220:223], v[56:59], v[64:79]
  ds_read_b64_tr_b16 v[40:41], v7 offset:25600
  ds_read_b64_tr_b16 v[42:43], v7 offset:25856
  v_dot2c_f32_bf16 v17, v222, v222
  v_dot2c_f32_bf16 v17, v223, v223
  s_waitcnt lgkmcnt(14)
  v_mfma_f32_32x32x16_bf16 v[80:95], v[220:223], v[60:63], v[80:95]
  ds_read_b64_tr_b16 v[44:45], v7 offset:58368
  ds_read_b64_tr_b16 v[46:47], v7 offset:58624
  s_waitcnt lgkmcnt(11)
  s_waitcnt lgkmcnt(7)
  v_mfma_f32_32x32x16_bf16 v[64:79], v[224:227], v[32:35], v[64:79]
  ds_read_b64_tr_b16 v[48:49], v7 offset:26624
  ds_read_b64_tr_b16 v[50:51], v7 offset:26880
  ds_read_b64_tr_b16 v[96:97], v10 offset:24576
  ds_read_b64_tr_b16 v[98:99], v10 offset:24832
  ds_read_b64_tr_b16 v[100:101], v10 offset:25600
  ds_read_b64_tr_b16 v[102:103], v10 offset:25856
  v_dot2c_f32_bf16 v16, v224, v18
  v_dot2c_f32_bf16 v16, v225, v18
  v_dot2c_f32_bf16 v16, v226, v18
  s_waitcnt lgkmcnt(11)
  v_mfma_f32_32x32x16_bf16 v[80:95], v[224:227], v[36:39], v[80:95]
  ds_read_b64_tr_b16 v[52:53], v7 offset:59392
  ds_read_b64_tr_b16 v[54:55], v7 offset:59648
  v_dot2c_f32_bf16 v16, v227, v18
  v_dot2c_f32_bf16 v17, v224, v224
  v_dot2c_f32_bf16 v17, v225, v225
  v_dot2c_f32_bf16 v17, v226, v226
  v_dot2c_f32_bf16 v17, v227, v227
  v_dot2c_f32_bf16 v16, v228, v18
  v_dot2c_f32_bf16 v16, v229, v18
  s_waitcnt lgkmcnt(10)
  v_mfma_f32_32x32x16_bf16 v[64:79], v[228:231], v[40:43], v[64:79]
  ds_read_b64_tr_b16 v[56:57], v7 offset:27648
  ds_read_b64_tr_b16 v[58:59], v7 offset:27904
  v_dot2c_f32_bf16 v16, v230, v18
  v_dot2c_f32_bf16 v16, v231, v18
  v_dot2c_f32_bf16 v17, v228, v228
  v_dot2c_f32_bf16 v17, v229, v229
  v_dot2c_f32_bf16 v17, v230, v230
  v_dot2c_f32_bf16 v17, v231, v231
  s_waitcnt lgkmcnt(4)
  v_dot2c_f32_bf16 v20, v96, v18
  v_mfma_f32_32x32x16_bf16 v[80:95], v[228:231], v[44:47], v[80:95]
  ds_read_b64_tr_b16 v[60:61], v7 offset:60416
  ds_read_b64_tr_b16 v[62:63], v7 offset:60672
  v_dot2c_f32_bf16 v20, v97, v18
  v_dot2c_f32_bf16 v20, v98, v18
  v_dot2c_f32_bf16 v20, v99, v18
  v_dot2c_f32_bf16 v20, v100, v18
  v_dot2c_f32_bf16 v20, v101, v18
  v_dot2c_f32_bf16 v20, v102, v18
  v_dot2c_f32_bf16 v20, v103, v18
  v_mfma_f32_32x32x16_bf16 v[64:79], v[232:235], v[48:51], v[64:79]
  ds_read_b64_tr_b16 v[32:33], v7 offset:28672
  ds_read_b64_tr_b16 v[34:35], v7 offset:28928
  v_dot2c_f32_bf16 v16, v232, v18
  v_dot2c_f32_bf16 v16, v233, v18
  v_dot2c_f32_bf16 v16, v234, v18
  v_dot2c_f32_bf16 v16, v235, v18
  v_dot2c_f32_bf16 v17, v232, v232
  v_dot2c_f32_bf16 v17, v233, v233
  v_dot2c_f32_bf16 v17, v234, v234
  v_dot2c_f32_bf16 v17, v235, v235
  s_waitcnt lgkmcnt(6)
  v_mfma_f32_32x32x16_bf16 v[80:95], v[232:235], v[52:55], v[80:95]
  ds_read_b64_tr_b16 v[36:37], v7 offset:61440
  ds_read_b64_tr_b16 v[38:39], v7 offset:61696
  s_waitcnt vmcnt(8)
  ds_write_b128 v26, v[240:243] offset:0
  ds_write_b128 v27, v[244:247] offset:1024
  ds_write_b128 v26, v[248:251] offset:2048
  ds_write_b128 v27, v[252:255] offset:3072
  ds_read_b128 v[240:243], v28
  ds_read_b128 v[244:247], v29
  ds_read_b128 v[248:251], v30
  s_waitcnt lgkmcnt(13)
  v_mfma_f32_32x32x16_bf16 v[64:79], v[236:239], v[56:59], v[64:79]
  ds_read_b64_tr_b16 v[40:41], v7 offset:29696
  ds_read_b64_tr_b16 v[42:43], v7 offset:29952
  ds_read_b128 v[252:255], v31
  v_dot2c_f32_bf16 v16, v236, v18
  v_dot2c_f32_bf16 v16, v237, v18
  v_dot2c_f32_bf16 v16, v238, v18
  v_dot2c_f32_bf16 v16, v239, v18
  v_dot2c_f32_bf16 v17, v236, v236
  v_dot2c_f32_bf16 v17, v237, v237
  s_waitcnt lgkmcnt(14)
  v_mfma_f32_32x32x16_bf16 v[80:95], v[236:239], v[60:63], v[80:95]
  ds_read_b64_tr_b16 v[44:45], v7 offset:62464
  ds_read_b64_tr_b16 v[46:47], v7 offset:62720
  v_dot2c_f32_bf16 v17, v238, v238
  v_dot2c_f32_bf16 v17, v239, v239
  s_waitcnt vmcnt(0)
  s_cmp_eq_u32 s73, 2
  s_cbranch_scc1 L5
  v_and_b32_e64 v104, 15, v0
  v_bfe_u32 v105, v0, 4, 1
  v_lshrrev_b32 v106, 5, v0
  v_lshrrev_b32 v107, 2, v104
  v_lshl_add_u32 v107, v106, 2, v107
  v_lshlrev_b32_e64 v107, 7, v107
  v_lshl_add_u32 v107, v105, 5, v107
  v_and_b32_e64 v108, 3, v0
  v_lshl_add_u32 v107, v108, 3, v107
  s_cmp_eq_u32 s73, 3
  s_cbranch_scc1 L6
  s_lshl_b32 s44, s14, 6
  s_add_u32 s44, s44, 65536
  v_add_u32 v107, s44, v107
  ds_read_b64_tr_b16 v[112:113], v107 offset:0
  ds_read_b64_tr_b16 v[114:115], v107 offset:1024
  ds_read_b64_tr_b16 v[116:117], v107 offset:2048
  ds_read_b64_tr_b16 v[118:119], v107 offset:3072
  ds_read_b64_tr_b16 v[120:121], v107 offset:4096
  ds_read_b64_tr_b16 v[122:123], v107 offset:5120
  ds_read_b64_tr_b16 v[124:125], v107 offset:6144
  ds_read_b64_tr_b16 v[126:127], v107 offset:7168
  v_lshlrev_b32_e64 v108, 15, v105
  v_lshl_add_u32 v108, v106, 9, v108
  v_lshl_add_u32 v108, v104, 4, v108
  v_lshlrev_b32_e64 v109, 10, v105
  v_lshl_add_u32 v109, v104, 4, v109
  v_mov_b32 v110, 0x3f803f80
  v_mov_b32 v111, 0
  s_waitcnt lgkmcnt(0)
  buffer_store_dwordx4 v[112:115], v108, s[4:7], s66 offen offset:0 sc0 sc1
  v_dot2c_f32_bf16 v111, v112, v110
  v_dot2c_f32_bf16 v111, v113, v110
  v_dot2c_f32_bf16 v111, v114, v110
  v_dot2c_f32_bf16 v111, v115, v110
  buffer_store_dwordx4 v[116:119], v108, s[4:7], s66 offen offset:1024 sc0 sc1
  v_dot2c_f32_bf16 v111, v116, v110
  v_dot2c_f32_bf16 v111, v117, v110
  v_dot2c_f32_bf16 v111, v118, v110
  v_dot2c_f32_bf16 v111, v119, v110
  buffer_store_dwordx4 v[120:123], v108, s[4:7], s66 offen offset:2048 sc0 sc1
  v_dot2c_f32_bf16 v111, v120, v110
  v_dot2c_f32_bf16 v111, v121, v110
  v_dot2c_f32_bf16 v111, v122, v110
  v_dot2c_f32_bf16 v111, v123, v110
  buffer_store_dwordx4 v[124:127], v108, s[4:7], s66 offen offset:3072 sc0 sc1
  v_dot2c_f32_bf16 v111, v124, v110
  v_dot2c_f32_bf16 v111, v125, v110
  v_dot2c_f32_bf16 v111, v126, v110
  v_dot2c_f32_bf16 v111, v127, v110
  ds_read_b64_tr_b16 v[112:113], v107 offset:8192
  ds_read_b64_tr_b16 v[114:115], v107 offset:9216
  ds_read_b64_tr_b16 v[116:117], v107 offset:10240
  ds_read_b64_tr_b16 v[118:119], v107 offset:11264
  ds_read_b64_tr_b16 v[120:121], v107 offset:12288
  ds_read_b64_tr_b16 v[122:123], v107 offset:13312
  ds_read_b64_tr_b16 v[124:125], v107 offset:14336
  ds_read_b64_tr_b16 v[126:127], v107 offset:15360
  s_add_u32 s66, s66, 4096
  s_waitcnt lgkmcnt(0)
  buffer_store_dwordx4 v[112:115], v108, s[4:7], s66 offen offset:0 sc0 sc1
  v_dot2c_f32_bf16 v111, v112, v110
  v_dot2c_f32_bf16 v111, v113, v110
  v_dot2c_f32_bf16 v111, v114, v110
  v_dot2c_f32_bf16 v111, v115, v110
  buffer_store_dwordx4 v[116:119], v108, s[4:7], s66 offen offset:1024 sc0 sc1
  v_dot2c_f32_bf16 v111, v116, v110
  v_dot2c_f32_bf16 v111, v117, v110
  v_dot2c_f32_bf16 v111, v118, v110
  v_dot2c_f32_bf16 v111, v119, v110
  buffer_store_dwordx4 v[120:123], v108, s[4:7], s66 offen offset:2048 sc0 sc1
  v_dot2c_f32_bf16 v111, v120, v110
  v_dot2c_f32_bf16 v111, v121, v110
  v_dot2c_f32_bf16 v111, v122, v110
  v_dot2c_f32_bf16 v111, v123, v110
  buffer_store_dwordx4 v[124:127], v108, s[4:7], s66 offen offset:3072 sc0 sc1
  v_dot2c_f32_bf16 v111, v124, v110
  v_dot2c_f32_bf16 v111, v125, v110
  v_dot2c_f32_bf16 v111, v126, v110
  v_dot2c_f32_bf16 v111, v127, v110
  s_nop 2
  v_mov_b32 v104, v111
  s_nop 1
  v_permlane32_swap_b32 v111, v104
  v_add_f32 v111, v111, v104
  v_cvt_pk_bf16_f32 v104, v111, v111
  v_and_b32 v106, 0xffff0000, v104
  v_sub_f32_e64 v106, v111, v106
  v_cvt_pk_bf16_f32 v105, v106, 0
  s_mov_b32 exec_hi, 0
  buffer_store_dwordx2 v[104:105], v109, s[4:7], s68 offen sc0 sc1
  s_mov_b64 exec, -1
  s_branch L5
L6:
  s_add_u32 s44, s22, 65536
  v_add_u32 v107, s44, v107
  ds_read_b64_tr_b16 v[112:113], v107 offset:0
  ds_read_b64_tr_b16 v[114:115], v107 offset:1024
  ds_read_b64_tr_b16 v[116:117], v107 offset:64
  ds_read_b64_tr_b16 v[118:119], v107 offset:1088
  ds_read_b64_tr_b16 v[120:121], v107 offset:2048
  ds_read_b64_tr_b16 v[122:123], v107 offset:3072
  ds_read_b64_tr_b16 v[124:125], v107 offset:2112
  ds_read_b64_tr_b16 v[126:127], v107 offset:3136
  s_waitcnt lgkmcnt(0)
  buffer_store_dwordx4 v[112:115], v1, s[4:7], s66 offen offset:0 sc0 sc1
  buffer_store_dwordx4 v[116:119], v1, s[4:7], s66 offen offset:1024 sc0 sc1
  buffer_store_dwordx4 v[120:123], v1, s[4:7], s66 offen offset:2048 sc0 sc1
  buffer_store_dwordx4 v[124:127], v1, s[4:7], s66 offen offset:3072 sc0 sc1
L5:
  s_nop 2
  s_load_dword s39, s[74:75], 0
  s_waitcnt lgkmcnt(7)
  v_mfma_f32_32x32x16_bf16 v[64:79], v[240:243], v[32:35], v[64:79]
  ds_read_b64_tr_b16 v[48:49], v7 offset:30720
  ds_read_b64_tr_b16 v[50:51], v7 offset:30976
  ds_read_b64_tr_b16 v[96:97], v10 offset:57344
  ds_read_b64_tr_b16 v[98:99], v10 offset:57600
  ds_read_b64_tr_b16 v[100:101], v10 offset:58368
  ds_read_b64_tr_b16 v[102:103], v10 offset:58624
  v_dot2c_f32_bf16 v16, v240, v18
  v_dot2c_f32_bf16 v16, v241, v18
  v_dot2c_f32_bf16 v16, v242, v18
  v_mfma_f32_32x32x16_bf16 v[80:95], v[240:243], v[36:39], v[80:95]
  ds_read_b64_tr_b16 v[52:53], v7 offset:63488
  ds_read_b64_tr_b16 v[54:55], v7 offset:63744
  v_dot2c_f32_bf16 v16, v243, v18
  v_dot2c_f32_bf16 v17, v240, v240
  v_dot2c_f32_bf16 v17, v241, v241
  v_dot2c_f32_bf16 v17, v242, v242
  v_dot2c_f32_bf16 v17, v243, v243
  s_waitcnt lgkmcnt(14)
  v_dot2c_f32_bf16 v16, v244, v18
  v_dot2c_f32_bf16 v16, v245, v18
  s_waitcnt lgkmcnt(11)
  v_mfma_f32_32x32x16_bf16 v[64:79], v[244:247], v[40:43], v[64:79]
  ds_read_b64_tr_b16 v[56:57], v7 offset:31744
  ds_read_b64_tr_b16 v[58:59], v7 offset:32000
  v_dot2c_f32_bf16 v16, v246, v18
  v_dot2c_f32_bf16 v16, v247, v18
  v_dot2c_f32_bf16 v17, v244, v244
  v_dot2c_f32_bf16 v17, v245, v245
  v_dot2c_f32_bf16 v17, v246, v246
  v_dot2c_f32_bf16 v17, v247, v247
  s_waitcnt lgkmcnt(4)
  v_dot2c_f32_bf16 v21, v96, v18
  v_mfma_f32_32x32x16_bf16 v[80:95], v[244:247], v[44:47], v[80:95]
  ds_read_b64_tr_b16 v[60:61], v7 offset:64512
  ds_read_b64_tr_b16 v[62:63], v7 offset:64768
  v_dot2c_f32_bf16 v21, v97, v18
  v_dot2c_f32_bf16 v21, v98, v18
  v_dot2c_f32_bf16 v21, v99, v18
  v_dot2c_f32_bf16 v21, v100, v18
  v_dot2c_f32_bf16 v21, v101, v18
  v_dot2c_f32_bf16 v21, v102, v18
  v_dot2c_f32_bf16 v21, v103, v18
  v_mfma_f32_32x32x16_bf16 v[64:79], v[248:251], v[48:51], v[64:79]
  v_dot2c_f32_bf16 v16, v248, v18
  v_dot2c_f32_bf16 v16, v249, v18
  v_dot2c_f32_bf16 v16, v250, v18
  v_dot2c_f32_bf16 v16, v251, v18
  v_dot2c_f32_bf16 v17, v248, v248
  v_dot2c_f32_bf16 v17, v249, v249
  v_dot2c_f32_bf16 v17, v250, v250
  v_dot2c_f32_bf16 v17, v251, v251
  s_waitcnt lgkmcnt(4)
  v_mfma_f32_32x32x16_bf16 v[80:95], v[248:251], v[52:55], v[80:95]
  v_dot2c_f32_bf16 v16, v252, v18
  v_dot2c_f32_bf16 v16, v253, v18
  v_dot2c_f32_bf16 v16, v254, v18
  v_dot2c_f32_bf16 v16, v255, v18
  v_dot2c_f32_bf16 v17, v252, v252
  v_dot2c_f32_bf16 v17, v253, v253
  v_dot2c_f32_bf16 v17, v254, v254
  s_waitcnt lgkmcnt(2)
  v_mfma_f32_32x32x16_bf16 v[64:79], v[252:255], v[56:59], v[64:79]
  v_dot2c_f32_bf16 v17, v255, v255
  s_waitcnt lgkmcnt(0)
  v_mfma_f32_32x32x16_bf16 v[80:95], v[252:255], v[60:63], v[80:95]
  v_mov_b32 v98, v20
  s_nop 1
  v_permlane32_swap_b32 v20, v98
  v_add_f32_e64 v20, v20, v98
  v_cvt_pk_bf16_f32 v96, v20, v20
  v_and_b32 v98, 0xffff0000, v96
  v_sub_f32_e64 v98, v20, v98
  v_cvt_pk_bf16_f32 v97, v98, 0
  s_lshr_b32 s44, s14, 1
  s_lshl_b32 s44, s44, 9
  s_and_b32 s45, s14, 1
  s_lshl_b32 s45, s45, 3
  s_add_u32 s44, s44, s45
  s_add_u32 s44, s44, 135168
  v_add_u32_e64 v99, s44, v1
  s_mov_b32 exec_hi, 0
  ds_write_b64 v99, v[96:97]
  s_mov_b64 exec, -1
  v_mov_b32 v102, v21
  s_nop 1
  v_permlane32_swap_b32 v21, v102
  v_add_f32_e64 v21, v21, v102
  v_cvt_pk_bf16_f32 v100, v21, v21
  v_and_b32 v102, 0xffff0000, v100
  v_sub_f32_e64 v102, v21, v102
  v_cvt_pk_bf16_f32 v101, v102, 0
  s_lshr_b32 s44, s14, 1
  s_lshl_b32 s44, s44, 9
  s_and_b32 s45, s14, 1
  s_lshl_b32 s45, s45, 3
  s_add_u32 s44, s44, s45
  s_add_u32 s44, s44, 136192
  v_add_u32_e64 v103, s44, v1
  s_mov_b32 exec_hi, 0
  ds_write_b64 v103, v[100:101]
  s_mov_b64 exec, -1
  v_mov_b32 v4, v23
  v_mov_b32 v18, v16
  v_mov_b32 v19, v17
  s_nop 0
  v_permlane32_swap_b32 v16, v18
  v_permlane32_swap_b32 v17, v19
  v_add_f32 v16, v16, v18
  v_add_f32_e64 v17, v17, v19
  v_mul_f32 v16, 0xbb000000, v16
  v_mul_f32 v17, 0x3b000000, v17
  v_fma_f32 v17, -v16, v16, v17
  v_max_f32_e64 v17, 0, v17
  v_add_f32 v17, 0x3727c5ac, v17
  v_rsq_f32_e64 v11, v17
  v_cvt_pk_bf16_f32 v13, v16, 0
  v_lshlrev_b32 v18, 16, v13
  v_sub_f32 v18, v16, v18
  v_cvt_pk_bf16_f32 v12, v16, v18
  v_mov_b32 v15, v13
  v_mov_b32 v14, v12
  v_accvgpr_read_b32 v18, a240
  ds_write_b32 v18, v11
  ds_read_b128 v[112:115], v9 offset:0
  ds_read_b128 v[116:119], v9 offset:32
  ds_read_b128 v[120:123], v9 offset:64
  ds_read_b128 v[124:127], v9 offset:96
  s_waitcnt lgkmcnt(0)
  s_barrier
  ds_read_b128 v[32:35], v3 offset:4096
  s_waitcnt lgkmcnt(0)
  v_mfma_f32_32x32x16_bf16 v[64:79], v[12:15], v[32:35], v[64:79]
  ds_read_b128 v[36:39], v3 offset:5120
  ds_read_b64_tr_b16 v[40:41], v8 offset:0
  ds_read_b64_tr_b16 v[42:43], v8 offset:256
  ds_read_b64_tr_b16 v[44:45], v8 offset:1024
  ds_read_b64_tr_b16 v[46:47], v8 offset:1280
  ds_read_b64_tr_b16 v[48:49], v8 offset:2048
  ds_read_b64_tr_b16 v[50:51], v8 offset:2304
  s_waitcnt lgkmcnt(6)
  v_mfma_f32_32x32x16_bf16 v[80:95], v[12:15], v[36:39], v[80:95]
  ds_read_b64_tr_b16 v[52:53], v8 offset:3072
  ds_read_b64_tr_b16 v[54:55], v8 offset:3328
  v_add_u32 v7, 98304, v10
  v_mov_b32 v5, v22
  s_waitcnt lgkmcnt(6)
  v_mfma_f32_32x32x16_bf16 v[96:111], v[40:43], v[128:131], 0
  ds_read_b64_tr_b16 v[56:57], v8 offset:4096
  ds_read_b64_tr_b16 v[58:59], v8 offset:4352
  v_pk_fma_f32 v[64:65], v[64:65], v[112:113], s[32:33] op_sel_hi:[1,1,0]
  v_pk_mul_f32 v[28:29], v[64:65], s[32:33] op_sel:[0,1] op_sel_hi:[1,1]
  v_exp_f32 v28, v28 clamp
  v_exp_f32 v29, v29 clamp
  v_max_f32 v64, s32, v64
  v_max_f32 v65, s32, v65
  v_pk_add_f32 v[64:65], v[64:65], v[28:29]
  v_mov_b64 v[24:25], v[64:65]
  v_cvt_pk_bf16_f32 v16, v64, v65
  v_pk_fma_f32 v[66:67], v[66:67], v[114:115], s[32:33] op_sel_hi:[1,1,0]
  v_pk_mul_f32 v[30:31], v[66:67], s[32:33] op_sel:[0,1] op_sel_hi:[1,1]
  s_waitcnt lgkmcnt(6)
  v_mfma_f32_32x32x16_bf16 v[96:111], v[44:47], v[132:135], v[96:111]
  ds_read_b64_tr_b16 v[60:61], v8 offset:5120
  ds_read_b64_tr_b16 v[62:63], v8 offset:5376
  v_exp_f32 v30, v30 clamp
  v_exp_f32 v31, v31 clamp
  v_max_f32 v66, s32, v66
  v_max_f32 v67, s32, v67
  v_pk_add_f32 v[66:67], v[66:67], v[30:31]
  v_pk_add_f32 v[24:25], v[24:25], v[66:67]
  v_cvt_pk_bf16_f32 v17, v66, v67
  v_pk_fma_f32 v[68:69], v[68:69], v[116:117], s[32:33] op_sel_hi:[1,1,0]
  v_pk_mul_f32 v[28:29], v[68:69], s[32:33] op_sel:[0,1] op_sel_hi:[1,1]
  v_exp_f32 v28, v28 clamp
  v_exp_f32 v29, v29 clamp
  v_max_f32 v68, s32, v68
  s_waitcnt lgkmcnt(6)
  v_mfma_f32_32x32x16_bf16 v[96:111], v[48:51], v[136:139], v[96:111]
  ds_read_b64_tr_b16 v[32:33], v8 offset:6144
  ds_read_b64_tr_b16 v[34:35], v8 offset:6400
  v_max_f32_e64 v69, s32, v69
  v_pk_add_f32 v[68:69], v[68:69], v[28:29]
  v_pk_add_f32 v[24:25], v[24:25], v[68:69]
  v_cvt_pk_bf16_f32 v18, v68, v69
  v_pk_fma_f32 v[70:71], v[70:71], v[118:119], s[32:33] op_sel_hi:[1,1,0]
  v_pk_mul_f32 v[30:31], v[70:71], s[32:33] op_sel:[0,1] op_sel_hi:[1,1]
  v_exp_f32 v30, v30 clamp
  v_exp_f32 v31, v31 clamp
  v_max_f32 v70, s32, v70
  v_max_f32 v71, s32, v71
  v_pk_add_f32 v[70:71], v[70:71], v[30:31]
  v_pk_add_f32 v[24:25], v[24:25], v[70:71]
  s_waitcnt lgkmcnt(6)
  v_mfma_f32_32x32x16_bf16 v[96:111], v[52:55], v[140:143], v[96:111]
  ds_read_b64_tr_b16 v[36:37], v8 offset:7168
  ds_read_b64_tr_b16 v[38:39], v8 offset:7424
  v_cvt_pk_bf16_f32 v19, v70, v71
  v_pk_fma_f32 v[72:73], v[72:73], v[120:121], s[32:33] op_sel_hi:[1,1,0]
  v_pk_mul_f32 v[28:29], v[72:73], s[32:33] op_sel:[0,1] op_sel_hi:[1,1]
  v_exp_f32 v28, v28 clamp
  v_exp_f32 v29, v29 clamp
  v_max_f32 v72, s32, v72
  v_max_f32_e64 v73, s32, v73
  v_pk_add_f32 v[72:73], v[72:73], v[28:29]
  v_pk_add_f32 v[24:25], v[24:25], v[72:73]
  v_cvt_pk_bf16_f32 v20, v72, v73
  v_pk_fma_f32 v[74:75], v[74:75], v[122:123], s[32:33] op_sel_hi:[1,1,0]
  v_pk_mul_f32 v[30:31], v[74:75], s[32:33] op_sel:[0,1] op_sel_hi:[1,1]
  s_waitcnt lgkmcnt(6)
  v_mfma_f32_32x32x16_bf16 v[96:111], v[56:59], v[144:147], v[96:111]
  ds_read_b64_tr_b16 v[40:41], v8 offset:8192
  ds_read_b64_tr_b16 v[42:43], v8 offset:8448
  v_exp_f32 v30, v30 clamp
  v_exp_f32 v31, v31 clamp
  v_max_f32 v74, s32, v74
  v_max_f32_e64 v75, s32, v75
  v_pk_add_f32 v[74:75], v[74:75], v[30:31]
  v_pk_add_f32 v[24:25], v[24:25], v[74:75]
  v_cvt_pk_bf16_f32 v21, v74, v75
  v_pk_fma_f32 v[76:77], v[76:77], v[124:125], s[32:33] op_sel_hi:[1,1,0]
  v_pk_mul_f32 v[28:29], v[76:77], s[32:33] op_sel:[0,1] op_sel_hi:[1,1]
  v_exp_f32 v28, v28 clamp
  v_exp_f32 v29, v29 clamp
  v_max_f32 v76, s32, v76
  s_waitcnt lgkmcnt(6)
  v_mfma_f32_32x32x16_bf16 v[96:111], v[60:63], v[148:151], v[96:111]
  ds_read_b64_tr_b16 v[44:45], v8 offset:9216
  ds_read_b64_tr_b16 v[46:47], v8 offset:9472
  v_max_f32_e64 v77, s32, v77
  v_pk_add_f32 v[76:77], v[76:77], v[28:29]
  v_pk_add_f32 v[24:25], v[24:25], v[76:77]
  v_cvt_pk_bf16_f32 v22, v76, v77
  v_pk_fma_f32 v[78:79], v[78:79], v[126:127], s[32:33] op_sel_hi:[1,1,0]
  v_pk_mul_f32 v[30:31], v[78:79], s[32:33] op_sel:[0,1] op_sel_hi:[1,1]
  v_exp_f32 v30, v30 clamp
  v_exp_f32 v31, v31 clamp
  v_max_f32 v78, s32, v78
  v_max_f32 v79, s32, v79
  v_pk_add_f32 v[78:79], v[78:79], v[30:31]
  v_pk_add_f32 v[24:25], v[24:25], v[78:79]
  s_waitcnt lgkmcnt(6)
  v_mfma_f32_32x32x16_bf16 v[96:111], v[32:35], v[152:155], v[96:111]
  ds_read_b64_tr_b16 v[48:49], v8 offset:10240
  ds_read_b64_tr_b16 v[50:51], v8 offset:10496
  v_cvt_pk_bf16_f32 v23, v78, v79
  v_pk_mul_f32 v[80:81], v[80:81], v[112:113]
  v_cvt_pk_bf16_f32 v112, v80, v81
  v_pk_mul_f32 v[82:83], v[82:83], v[114:115]
  v_cvt_pk_bf16_f32 v113, v82, v83
  v_pk_mul_f32 v[84:85], v[84:85], v[116:117]
  v_cvt_pk_bf16_f32 v114, v84, v85
  v_pk_mul_f32 v[86:87], v[86:87], v[118:119]
  v_cvt_pk_bf16_f32 v115, v86, v87
  v_pk_mul_f32 v[88:89], v[88:89], v[120:121]
  v_cvt_pk_bf16_f32 v116, v88, v89
  v_pk_mul_f32 v[90:91], v[90:91], v[122:123]
  s_waitcnt lgkmcnt(6)
  v_mfma_f32_32x32x16_bf16 v[96:111], v[36:39], v[156:159], v[96:111]
  ds_read_b64_tr_b16 v[52:53], v8 offset:11264
  ds_read_b64_tr_b16 v[54:55], v8 offset:11520
  v_cvt_pk_bf16_f32 v117, v90, v91
  v_pk_mul_f32 v[92:93], v[92:93], v[124:125]
  v_cvt_pk_bf16_f32 v118, v92, v93
  v_pk_mul_f32 v[94:95], v[94:95], v[126:127]
  v_cvt_pk_bf16_f32 v119, v94, v95
  v_add_f32_e64 v10, v24, v25
  v_mfma_f32_32x32x16_bf16 v[64:79], v[16:19], v[112:115], 0
  v_mfma_f32_32x32x16_bf16 v[64:79], v[20:23], v[116:119], v[64:79]
  v_mov_b32_e64 v24, v10
  v_accvgpr_read_b32 v25, a241
  v_accvgpr_read_b32 v26, a244
  v_permlane32_swap_b32 v24, v10
  s_waitcnt lgkmcnt(6)
  v_mfma_f32_32x32x16_bf16 v[96:111], v[40:43], v[160:163], v[96:111]
  ds_read_b64_tr_b16 v[56:57], v8 offset:12288
  ds_read_b64_tr_b16 v[58:59], v8 offset:12544
  v_add_f32_e64 v24, v24, v10
  s_mul_i32 s49, s18, 2176
  s_add_u32 s49, s49, s16
  s_add_u32 s49, s49, 2359296
  ds_write_b32 v26, v24
  s_mov_b32 exec_lo, 0x0000ffff
  s_mov_b32 exec_hi, 0x0000ffff
  ds_write_b128 v25, v[64:67]
  ds_write_b128 v25, v[68:71] offset:16
  s_mov_b32 exec_lo, 0xffff0000
  s_mov_b32 exec_hi, 0xffff0000
  ds_write_b128 v25, v[72:75]
  ds_write_b128 v25, v[76:79] offset:16
  s_mov_b64 exec, -1
  v_accvgpr_read_b32 v25, a242
  v_accvgpr_read_b32 v27, a243
  s_cmp_lg_u32 s14, 0
  s_cbranch_scc1 L7
  s_cmp_ge_u32 s39, 27
  s_cbranch_scc1 L7
  s_mov_b32 s50, 0
PL8:
  s_load_dword s51, s[74:75], 0 glc
  s_waitcnt lgkmcnt(0)
  s_cmp_ge_u32 s51, 27
  s_cbranch_scc1 PD9
  s_sleep 16
  s_add_u32 s50, s50, 1
  s_cmp_lt_u32 s50, 20000
  s_cbranch_scc1 PL8
PD9:
L7:
  s_waitcnt lgkmcnt(0)
  s_barrier
  ds_read2st64_b32 v[16:17], v25 offset0:0 offset1:1
  ds_read2st64_b32 v[18:19], v25 offset0:9 offset1:10
  ds_read2st64_b32 v[20:21], v25 offset0:18 offset1:19
  ds_read2st64_b32 v[22:23], v25 offset0:27 offset1:28
  ds_read_b32 v80, v25 offset:512
  ds_read_b32 v81, v25 offset:2816
  ds_read_b32 v82, v25 offset:5120
  ds_read_b32 v83, v25 offset:7424
  s_waitcnt lgkmcnt(4)
  v_pk_add_f32 v[16:17], v[16:17], v[18:19]
  v_pk_add_f32 v[20:21], v[20:21], v[22:23]
  v_mfma_f32_32x32x16_bf16 v[96:111], v[44:47], v[164:167], v[96:111]
  ds_read_b64_tr_b16 v[60:61], v8 offset:13312
  ds_read_b64_tr_b16 v[62:63], v8 offset:13568
  v_pk_add_f32 v[16:17], v[16:17], v[20:21]
  buffer_atomic_add_f32 v16, v27, s[4:7], s49 offen
  buffer_atomic_add_f32 v17, v27, s[4:7], s49 offen offset:256
  s_waitcnt lgkmcnt(2)
  v_pk_add_f32 v[80:81], v[80:81], v[82:83]
  v_add_f32 v80, v80, v81
  s_mov_b64 exec, 0xff
  buffer_atomic_add_f32 v80, v27, s[4:7], s49 offen offset:512
  s_mov_b64 exec, -1
  s_cmp_eq_u32 s14, 3
  s_cbranch_scc1 L10
  s_lshl_b32 s44, s14, 15
  s_cmp_eq_u32 s14, 2
  s_cselect_b32 s44, 98304, s44
  s_lshl_b32 s45, s26, 1
  s_sub_u32 s45, s17, s45
  s_and_b32 s45, s45, 15
  s_lshl_b32 s45, s45, 11
  s_add_u32 s44, s44, s45
  s_lshl_b32 s45, s17, 11
  v_add_u32 v22, s44, v5
  ds_read_b64_tr_b16 v[88:89], v22 offset:0
  ds_read_b64_tr_b16 v[90:91], v22 offset:512
  ds_read_b64_tr_b16 v[92:93], v22 offset:1024
  ds_read_b64_tr_b16 v[94:95], v22 offset:1536
  s_lshl_b32 s44, s17, 12
  s_add_u32 s44, s44, s23
  s_add_u32 s45, s45, 65536
  s_cmp_eq_u32 s14, 2
  s_cselect_b32 s44, s45, s44
  s_cselect_b32 s45, 1, 2
  s_lshl_b32 s45, s45, 10
  s_mul_i32 s46, s18, 98304
  s_add_u32 s44, s44, s46
  s_add_u32 s45, s45, s44
  s_waitcnt lgkmcnt(0)
  buffer_store_dwordx4 v[88:91], v1, s[4:7], s44 offen sc0 sc1
  buffer_store_dwordx4 v[92:95], v1, s[4:7], s45 offen sc0 sc1
L10:
  s_nop 1
  v_mfma_f32_32x32x16_bf16 v[96:111], v[48:51], v[168:171], v[96:111]
  ds_read_b64_tr_b16 v[32:33], v8 offset:14336
  ds_read_b64_tr_b16 v[34:35], v8 offset:14592
  v_mfma_f32_32x32x16_bf16 v[96:111], v[52:55], v[172:175], v[96:111]
  ds_read_b64_tr_b16 v[36:37], v8 offset:15360
  ds_read_b64_tr_b16 v[38:39], v8 offset:15616
  v_mov_b32 v18, 0x3f803f80
  v_mov_b32_e64 v20, 0
  ds_read_b64_tr_b16 v[64:65], v7 offset:0
  ds_read_b64_tr_b16 v[66:67], v7 offset:256
  ds_read_b64_tr_b16 v[68:69], v7 offset:1024
  ds_read_b64_tr_b16 v[70:71], v7 offset:1280
  ds_read_b64_tr_b16 v[72:73], v7 offset:8192
  ds_read_b64_tr_b16 v[74:75], v7 offset:8448
  ds_read_b64_tr_b16 v[76:77], v7 offset:9216
  ds_read_b64_tr_b16 v[78:79], v7 offset:9472
  s_waitcnt lgkmcnt(4)
  v_dot2c_f32_bf16 v20, v64, v18
  v_dot2c_f32_bf16 v20, v65, v18
  v_dot2c_f32_bf16 v20, v66, v18
  v_dot2c_f32_bf16 v20, v67, v18
  v_dot2c_f32_bf16 v20, v68, v18
  v_dot2c_f32_bf16 v20, v69, v18
  v_dot2c_f32_bf16 v20, v70, v18
  v_dot2c_f32_bf16 v20, v71, v18
  s_waitcnt lgkmcnt(0)
  v_dot2c_f32_bf16 v20, v72, v18
  v_dot2c_f32_bf16 v20, v73, v18
  v_dot2c_f32_bf16 v20, v74, v18
  v_dot2c_f32_bf16 v20, v75, v18
  v_dot2c_f32_bf16 v20, v76, v18
  v_dot2c_f32_bf16 v20, v77, v18
  v_dot2c_f32_bf16 v20, v78, v18
  v_dot2c_f32_bf16 v20, v79, v18
  ds_read_b64_tr_b16 v[64:65], v7 offset:16384
  ds_read_b64_tr_b16 v[66:67], v7 offset:16640
  ds_read_b64_tr_b16 v[68:69], v7 offset:17408
  ds_read_b64_tr_b16 v[70:71], v7 offset:17664
  ds_read_b64_tr_b16 v[72:73], v7 offset:24576
  ds_read_b64_tr_b16 v[74:75], v7 offset:24832
  ds_read_b64_tr_b16 v[76:77], v7 offset:25600
  ds_read_b64_tr_b16 v[78:79], v7 offset:25856
  s_waitcnt lgkmcnt(4)
  v_dot2c_f32_bf16 v20, v64, v18
  v_dot2c_f32_bf16 v20, v65, v18
  v_dot2c_f32_bf16 v20, v66, v18
  v_dot2c_f32_bf16 v20, v67, v18
  v_dot2c_f32_bf16 v20, v68, v18
  v_dot2c_f32_bf16 v20, v69, v18
  v_dot2c_f32_bf16 v20, v70, v18
  v_dot2c_f32_bf16 v20, v71, v18
  s_waitcnt lgkmcnt(0)
  v_dot2c_f32_bf16 v20, v72, v18
  v_dot2c_f32_bf16 v20, v73, v18
  v_dot2c_f32_bf16 v20, v74, v18
  v_dot2c_f32_bf16 v20, v75, v18
  v_dot2c_f32_bf16 v20, v76, v18
  v_dot2c_f32_bf16 v20, v77, v18
  v_dot2c_f32_bf16 v20, v78, v18
  v_dot2c_f32_bf16 v20, v79, v18
  s_nop 2
  v_mov_b32 v66, v20
  s_nop 1
  v_permlane32_swap_b32 v20, v66
  v_add_f32_e64 v20, v20, v66
  v_cvt_pk_bf16_f32 v64, v20, v20
  v_and_b32 v66, 0xffff0000, v64
  v_sub_f32_e64 v66, v20, v66
  v_cvt_pk_bf16_f32 v65, v66, 0
  s_lshr_b32 s44, s14, 1
  s_lshl_b32 s44, s44, 9
  s_and_b32 s45, s14, 1
  s_lshl_b32 s45, s45, 3
  s_add_u32 s44, s44, s45
  s_add_u32 s44, s44, 137216
  v_add_u32_e64 v67, s44, v1
  s_mov_b32 exec_hi, 0
  ds_write_b64 v67, v[64:65]
  s_mov_b64 exec, -1
  s_waitcnt lgkmcnt(0)
  v_mfma_f32_32x32x16_bf16 v[96:111], v[56:59], v[176:179], v[96:111]
  ds_read_b64_tr_b16 v[40:41], v8 offset:16384
  ds_read_b64_tr_b16 v[42:43], v8 offset:16640
  v_mfma_f32_32x32x16_bf16 v[96:111], v[60:63], v[180:183], v[96:111]
  ds_read_b64_tr_b16 v[44:45], v8 offset:17408
  ds_read_b64_tr_b16 v[46:47], v8 offset:17664
  v_mfma_f32_32x32x16_bf16 v[96:111], v[32:35], v[184:187], v[96:111]
  ds_read_b64_tr_b16 v[48:49], v8 offset:18432
  ds_read_b64_tr_b16 v[50:51], v8 offset:18688
  v_mfma_f32_32x32x16_bf16 v[96:111], v[36:39], v[188:191], v[96:111]
  ds_read_b64_tr_b16 v[52:53], v8 offset:19456
  ds_read_b64_tr_b16 v[54:55], v8 offset:19712
  s_waitcnt lgkmcnt(6)
  v_mfma_f32_32x32x16_bf16 v[96:111], v[40:43], v[192:195], v[96:111]
  ds_read_b64_tr_b16 v[56:57], v8 offset:20480
  ds_read_b64_tr_b16 v[58:59], v8 offset:20736
  s_waitcnt lgkmcnt(6)
  v_mfma_f32_32x32x16_bf16 v[96:111], v[44:47], v[196:199], v[96:111]
  ds_read_b64_tr_b16 v[60:61], v8 offset:21504
  ds_read_b64_tr_b16 v[62:63], v8 offset:21760
  s_waitcnt lgkmcnt(6)
  v_mfma_f32_32x32x16_bf16 v[96:111], v[48:51], v[200:203], v[96:111]
  ds_read_b64_tr_b16 v[32:33], v8 offset:22528
  ds_read_b64_tr_b16 v[34:35], v8 offset:22784
  s_waitcnt lgkmcnt(6)
  v_mfma_f32_32x32x16_bf16 v[96:111], v[52:55], v[204:207], v[96:111]
  ds_read_b64_tr_b16 v[36:37], v8 offset:23552
  ds_read_b64_tr_b16 v[38:39], v8 offset:23808
  s_waitcnt lgkmcnt(6)
  v_mfma_f32_32x32x16_bf16 v[96:111], v[56:59], v[208:211], v[96:111]
  ds_read_b64_tr_b16 v[40:41], v8 offset:24576
  ds_read_b64_tr_b16 v[42:43], v8 offset:24832
  s_waitcnt lgkmcnt(6)
  v_mfma_f32_32x32x16_bf16 v[96:111], v[60:63], v[212:215], v[96:111]
  ds_read_b64_tr_b16 v[44:45], v8 offset:25600
  ds_read_b64_tr_b16 v[46:47], v8 offset:25856
  s_waitcnt lgkmcnt(6)
  v_mfma_f32_32x32x16_bf16 v[96:111], v[32:35], v[216:219], v[96:111]
  ds_read_b64_tr_b16 v[48:49], v8 offset:26624
  ds_read_b64_tr_b16 v[50:51], v8 offset:26880
  s_waitcnt lgkmcnt(6)
  v_mfma_f32_32x32x16_bf16 v[96:111], v[36:39], v[220:223], v[96:111]
  ds_read_b64_tr_b16 v[52:53], v8 offset:27648
  ds_read_b64_tr_b16 v[54:55], v8 offset:27904
  s_waitcnt vmcnt(0)
  s_barrier
  s_cmp_lg_u32 s14, 3
  s_cbranch_scc1 L11
  v_lshlrev_b32 v28, 7, v0
  v_mov_b32_e64 v29, 1
  s_lshr_b32 s44, s18, 1
  s_lshl_b32 s44, s44, 11
  s_add_u32 s44, s44, s16
  s_add_u32 s44, s44, 2420736
  s_mov_b64 exec, 0xffff
  buffer_atomic_add v29, v28, s[4:7], s44 offen sc1
  s_mov_b64 exec, -1
L11:
  s_waitcnt lgkmcnt(6)
  v_mfma_f32_32x32x16_bf16 v[96:111], v[40:43], v[224:227], v[96:111]
  ds_read_b64_tr_b16 v[56:57], v8 offset:28672
  ds_read_b64_tr_b16 v[58:59], v8 offset:28928
  s_waitcnt lgkmcnt(6)
  v_mfma_f32_32x32x16_bf16 v[96:111], v[44:47], v[228:231], v[96:111]
  ds_read_b64_tr_b16 v[60:61], v8 offset:29696
  ds_read_b64_tr_b16 v[62:63], v8 offset:29952
  s_waitcnt lgkmcnt(6)
  v_mfma_f32_32x32x16_bf16 v[96:111], v[48:51], v[232:235], v[96:111]
  ds_read_b64_tr_b16 v[32:33], v8 offset:30720
  ds_read_b64_tr_b16 v[34:35], v8 offset:30976
  s_waitcnt lgkmcnt(6)
  v_mfma_f32_32x32x16_bf16 v[96:111], v[52:55], v[236:239], v[96:111]
  ds_read_b64_tr_b16 v[36:37], v8 offset:31744
  ds_read_b64_tr_b16 v[38:39], v8 offset:32000
  s_waitcnt lgkmcnt(6)
  v_mfma_f32_32x32x16_bf16 v[96:111], v[56:59], v[240:243], v[96:111]
  ds_read_b128 v[40:43], v3 offset:6144
  s_waitcnt lgkmcnt(5)
  v_mfma_f32_32x32x16_bf16 v[96:111], v[60:63], v[244:247], v[96:111]
  s_waitcnt lgkmcnt(3)
  v_mfma_f32_32x32x16_bf16 v[96:111], v[32:35], v[248:251], v[96:111]
  s_waitcnt lgkmcnt(1)
  v_mfma_f32_32x32x16_bf16 v[96:111], v[36:39], v[252:255], v[96:111]
  s_lshl_b32 s44, s19, 16
  s_add_u32 s44, s44, s22
  s_lshl_b32 s45, s20, 7
  s_add_u32 s44, s44, s45
  s_add_u32 s45, s44, 0x8000
  buffer_load_dwordx2 a[0:1], v4, s[8:11], s44 offen offset:0
  buffer_load_dwordx2 a[2:3], v4, s[8:11], s44 offen offset:16
  buffer_load_dwordx2 a[4:5], v4, s[8:11], s45 offen offset:0
  buffer_load_dwordx2 a[6:7], v4, s[8:11], s45 offen offset:16
  s_mov_b32 s8, s72
  s_mov_b32 s9, s3
  buffer_load_dword v5, off, s[8:11], 0 sc1
  s_waitcnt lgkmcnt(0)
  v_mfma_f32_32x32x16_bf16 v[96:111], v[40:43], v[12:15], v[96:111]
  s_barrier
  s_lshl_b32 s44, s18, 11
  s_add_u32 s49, s34, s44
  v_mov_b32_e64 v24, v11
  s_nop 7
  v_pk_fma_f32 v[96:97], v[96:97], v[24:25], s[32:33] op_sel_hi:[1,0,0]
  v_pk_mul_f32 v[28:29], v[96:97], s[32:33] op_sel:[0,1] op_sel_hi:[1,1]
  v_exp_f32 v28, v28 clamp
  v_exp_f32 v29, v29 clamp
  v_max_f32 v96, s32, v96
  v_max_f32 v97, s32, v97
  v_pk_add_f32 v[96:97], v[96:97], v[28:29]
  v_cvt_pk_bf16_f32 v16, v96, v97
  v_pk_fma_f32 v[98:99], v[98:99], v[24:25], s[32:33] op_sel_hi:[1,0,0]
  v_pk_mul_f32 v[30:31], v[98:99], s[32:33] op_sel:[0,1] op_sel_hi:[1,1]
  v_exp_f32 v30, v30 clamp
  v_exp_f32 v31, v31 clamp
  v_max_f32 v98, s32, v98
  v_max_f32 v99, s32, v99
  v_pk_add_f32 v[98:99], v[98:99], v[30:31]
  v_cvt_pk_bf16_f32 v17, v98, v99
  v_pk_fma_f32 v[100:101], v[100:101], v[24:25], s[32:33] op_sel_hi:[1,0,0]
  v_pk_mul_f32 v[28:29], v[100:101], s[32:33] op_sel:[0,1] op_sel_hi:[1,1]
  v_exp_f32 v28, v28 clamp
  v_exp_f32 v29, v29 clamp
  v_max_f32 v100, s32, v100
  v_max_f32 v101, s32, v101
  v_pk_add_f32 v[100:101], v[100:101], v[28:29]
  v_cvt_pk_bf16_f32 v18, v100, v101
  v_pk_fma_f32 v[102:103], v[102:103], v[24:25], s[32:33] op_sel_hi:[1,0,0]
  v_pk_mul_f32 v[30:31], v[102:103], s[32:33] op_sel:[0,1] op_sel_hi:[1,1]
  v_exp_f32 v30, v30 clamp
  v_exp_f32 v31, v31 clamp
  v_max_f32 v102, s32, v102
  v_max_f32 v103, s32, v103
  v_pk_add_f32 v[102:103], v[102:103], v[30:31]
  v_cvt_pk_bf16_f32 v19, v102, v103
  s_add_u32 s48, s49, 3145728
  buffer_store_dwordx4 v[16:19], v1, s[4:7], s48 offen offset:0 sc0 sc1
  v_pk_fma_f32 v[104:105], v[104:105], v[24:25], s[32:33] op_sel_hi:[1,0,0]
  v_pk_mul_f32 v[28:29], v[104:105], s[32:33] op_sel:[0,1] op_sel_hi:[1,1]
  v_exp_f32 v28, v28 clamp
  v_exp_f32 v29, v29 clamp
  v_max_f32 v104, s32, v104
  v_max_f32 v105, s32, v105
  v_pk_add_f32 v[104:105], v[104:105], v[28:29]
  v_cvt_pk_bf16_f32 v20, v104, v105
  v_pk_fma_f32 v[106:107], v[106:107], v[24:25], s[32:33] op_sel_hi:[1,0,0]
  v_pk_mul_f32 v[30:31], v[106:107], s[32:33] op_sel:[0,1] op_sel_hi:[1,1]
  v_exp_f32 v30, v30 clamp
  v_exp_f32 v31, v31 clamp
  v_max_f32 v106, s32, v106
  v_max_f32 v107, s32, v107
  v_pk_add_f32 v[106:107], v[106:107], v[30:31]
  v_cvt_pk_bf16_f32 v21, v106, v107
  v_pk_fma_f32 v[108:109], v[108:109], v[24:25], s[32:33] op_sel_hi:[1,0,0]
  v_pk_mul_f32 v[28:29], v[108:109], s[32:33] op_sel:[0,1] op_sel_hi:[1,1]
  v_exp_f32 v28, v28 clamp
  v_exp_f32 v29, v29 clamp
  v_max_f32 v108, s32, v108
  v_max_f32 v109, s32, v109
  v_pk_add_f32 v[108:109], v[108:109], v[28:29]
  v_cvt_pk_bf16_f32 v22, v108, v109
  v_pk_fma_f32 v[110:111], v[110:111], v[24:25], s[32:33] op_sel_hi:[1,0,0]
  v_pk_mul_f32 v[30:31], v[110:111], s[32:33] op_sel:[0,1] op_sel_hi:[1,1]
  v_exp_f32 v30, v30 clamp
  v_exp_f32 v31, v31 clamp
  v_max_f32 v110, s32, v110
  v_max_f32 v111, s32, v111
  v_pk_add_f32 v[110:111], v[110:111], v[30:31]
  v_cvt_pk_bf16_f32 v23, v110, v111
  buffer_store_dwordx4 v[20:23], v1, s[4:7], s48 offen offset:1024 sc0 sc1
  s_waitcnt vmcnt(2)
  v_accvgpr_read_b32 v24, a0
  v_lshlrev_b32 v25, 16, v24
  v_and_b32 v26, 0xffff0000, v24
  v_accvgpr_write_b32 a224, v25
  v_accvgpr_write_b32 a225, v26
  v_accvgpr_read_b32 v24, a1
  v_lshlrev_b32_e64 v25, 16, v24
  v_and_b32 v26, 0xffff0000, v24
  v_accvgpr_write_b32 a226, v25
  v_accvgpr_write_b32 a227, v26
  v_accvgpr_read_b32 v24, a2
  v_lshlrev_b32_e64 v25, 16, v24
  v_and_b32 v26, 0xffff0000, v24
  v_accvgpr_write_b32 a228, v25
  v_accvgpr_write_b32 a229, v26
  v_accvgpr_read_b32 v24, a3
  v_lshlrev_b32_e64 v25, 16, v24
  v_and_b32 v26, 0xffff0000, v24
  v_accvgpr_write_b32 a230, v25
  v_accvgpr_write_b32 a231, v26
  v_accvgpr_read_b32 v24, a4
  v_lshlrev_b32_e64 v25, 16, v24
  v_and_b32 v26, 0xffff0000, v24
  v_accvgpr_write_b32 a232, v25
  v_accvgpr_write_b32 a233, v26
  v_accvgpr_read_b32 v24, a5
  v_lshlrev_b32_e64 v25, 16, v24
  v_and_b32 v26, 0xffff0000, v24
  v_accvgpr_write_b32 a234, v25
  v_accvgpr_write_b32 a235, v26
  v_accvgpr_read_b32 v24, a6
  v_lshlrev_b32_e64 v25, 16, v24
  v_and_b32 v26, 0xffff0000, v24
  v_accvgpr_write_b32 a236, v25
  v_accvgpr_write_b32 a237, v26
  v_accvgpr_read_b32 v24, a7
  v_lshlrev_b32_e64 v25, 16, v24
  v_and_b32 v26, 0xffff0000, v24
  v_accvgpr_write_b32 a238, v25
  v_accvgpr_write_b32 a239, v26
  v_and_b32_e64 v24, 7, v0
  v_bfe_u32 v25, v0, 3, 2
  v_lshrrev_b32 v26, 5, v0
  v_and_b32 v27, 31, v0
  v_lshlrev_b32_e64 v29, 10, v24
  v_lshl_add_u32 v29, v25, 5, v29
  v_lshl_add_u32 v7, v26, 4, v29
  v_lshlrev_b32_e64 v28, 4, v24
  v_lshl_add_u32 v28, v26, 9, v28
  v_lshl_add_u32 v5, v25, 10, v28
  s_lshl_b32 s44, s14, 7
  v_add_u32 v29, s44, v28
  v_lshrrev_b32 v30, 1, v25
  v_lshlrev_b32 v30, 7, v30
  v_xor_b32_e64 v29, v29, v30
  v_lshl_add_u32 v29, v25, 11, v29
  v_add_u32 v4, 65536, v29
  v_min_u32 v29, 16, v27
  v_lshlrev_b32 v29, 6, v29
  v_lshl_add_u32 v29, v26, 5, v29
  s_add_u32 s44, s24, 98304
  v_add_u32 v8, s44, v29
M_wo:
  v_lshrrev_b32 v28, 3, v0
  v_and_b32 v29, 7, v0
  v_lshlrev_b32 v28, 10, v28
  v_lshl_add_u32 v28, v29, 4, v28
  s_add_u32 s46, s27, 0
  s_add_u32 m0, s22, 0
  s_nop 0
  buffer_load_dwordx4 v28, s[92:95], s46 offen lds
  s_add_u32 s46, s27, 8192
  s_add_u32 m0, s22, 1024
  s_nop 0
  buffer_load_dwordx4 v28, s[92:95], s46 offen lds
  s_add_u32 s46, s27, 16384
  s_add_u32 m0, s22, 2048
  s_nop 0
  buffer_load_dwordx4 v28, s[92:95], s46 offen lds
  s_add_u32 s46, s27, 24576
  s_add_u32 m0, s22, 3072
  s_nop 0
  buffer_load_dwordx4 v28, s[92:95], s46 offen lds
  s_add_u32 s46, s27, 32768
  s_add_u32 m0, s22, 4096
  s_nop 0
  buffer_load_dwordx4 v28, s[92:95], s46 offen lds
  s_add_u32 s46, s27, 40960
  s_add_u32 m0, s22, 5120
  s_nop 0
  buffer_load_dwordx4 v28, s[92:95], s46 offen lds
  s_waitcnt vmcnt(6)
  s_lshl_b32 s44, s21, 7
  s_add_u32 s44, s44, 8192
  s_mov_b32 s52, 1
  s_atomic_add s52, s[12:13], s44
  s_and_b32 s53, s2, 15
  s_lshl_b32 s53, s53, 7
  s_lshl_b32 s44, s14, 12
  s_add_u32 s53, s53, s44
  s_add_u32 s53, s53, 24576
  s_add_u32 s54, s53, 2048
  s_mov_b32 s60, 0
  s_mov_b32 s61, 0
  s_atomic_add s60, s[12:13], s53 glc
  s_atomic_add s61, s[12:13], s54 glc
  s_add_u32 s46, s27, 49152
  s_add_u32 m0, s22, 6144
  s_nop 0
  buffer_load_dwordx4 v28, s[92:95], s46 offen lds
  s_add_u32 s46, s27, 57344
  s_add_u32 m0, s22, 7168
  s_nop 0
  buffer_load_dwordx4 v28, s[92:95], s46 offen lds
  s_add_u32 s46, s27, 65536
  s_add_u32 m0, s22, 32768
  s_nop 0
  buffer_load_dwordx4 v28, s[92:95], s46 offen lds
  s_add_u32 s46, s27, 73728
  s_add_u32 m0, s22, 33792
  s_nop 0
  buffer_load_dwordx4 v28, s[92:95], s46 offen lds
  s_add_u32 s46, s27, 81920
  s_add_u32 m0, s22, 34816
  s_nop 0
  buffer_load_dwordx4 v28, s[92:95], s46 offen lds
  s_add_u32 s46, s27, 90112
  s_add_u32 m0, s22, 35840
  s_nop 0
  buffer_load_dwordx4 v28, s[92:95], s46 offen lds
  s_add_u32 s46, s27, 98304
  s_add_u32 m0, s22, 36864
  s_nop 0
  buffer_load_dwordx4 v28, s[92:95], s46 offen lds
  s_add_u32 s46, s27, 106496
  s_add_u32 m0, s22, 37888
  s_nop 0
  buffer_load_dwordx4 v28, s[92:95], s46 offen lds
  s_add_u32 s46, s27, 114688
  s_add_u32 m0, s22, 38912
  s_nop 0
  buffer_load_dwordx4 v28, s[92:95], s46 offen lds
  s_add_u32 s46, s27, 122880
  s_add_u32 m0, s22, 39936
  s_nop 0
  buffer_load_dwordx4 v28, s[92:95], s46 offen lds
  v_bfe_u32 v28, v0, 2, 2
  v_lshrrev_b32 v29, 5, v0
  v_lshl_add_u32 v28, v29, 2, v28
  v_lshlrev_b32_e64 v28, 7, v28
  v_bfe_u32 v29, v0, 4, 1
  v_lshl_add_u32 v28, v29, 5, v28
  v_and_b32_e64 v29, 3, v0
  v_lshl_add_u32 v28, v29, 3, v28
  v_add_u32 v28, s22, v28
  s_mov_b32 s50, 0
PL12:
  s_waitcnt lgkmcnt(0)
  s_min_u32 s60, s60, s61
  s_cmp_ge_u32 s60, 32
  s_cbranch_scc1 PD13
  s_mov_b32 s60, 0
  s_mov_b32 s61, 0
  s_atomic_add s60, s[12:13], s53 glc
  s_atomic_add s61, s[12:13], s54 glc
  s_add_u32 s50, s50, 1
  s_cmp_lt_u32 s50, 20000
  s_cbranch_scc1 PL12
  s_waitcnt lgkmcnt(0)
PD13:
  s_lshl_b32 s45, s19, 1
  s_add_u32 s45, s45, s14
  s_add_u32 s45, s45, 64
  s_lshl_b32 s45, s45, 7
  s_mul_i32 s49, s14, 8704
  s_add_u32 s49, s49, s16
  s_lshl_b32 s53, s19, 8
  s_add_u32 s53, s53, 8192
  s_add_u32 s54, s53, 128
  s_mov_b32 s60, 0
  s_mov_b32 s61, 0
  s_atomic_add s60, s[12:13], s53 glc
  s_atomic_add s61, s[12:13], s54 glc
  s_add_u32 s46, s49, 2359296
  s_add_u32 m0, s24, 98304
  s_nop 0
  buffer_load_dwordx4 v1, s[4:7], s46 offen offset:0 sc1 lds
  buffer_load_dwordx4 v1, s[4:7], s46 offen offset:1024 sc1 lds
  buffer_load_dwordx4 v1, s[4:7], s46 offen offset:2048 sc1 lds
  buffer_load_dwordx4 v1, s[4:7], s46 offen offset:3072 sc1 lds
  s_add_u32 s46, s49, 2363392
  s_add_u32 m0, s24, 102400
  s_nop 0
  buffer_load_dwordx4 v1, s[4:7], s46 offen offset:0 sc1 lds
  buffer_load_dwordx4 v1, s[4:7], s46 offen offset:1024 sc1 lds
  buffer_load_dwordx4 v1, s[4:7], s46 offen offset:2048 sc1 lds
  buffer_load_dwordx4 v1, s[4:7], s46 offen offset:3072 sc1 lds
  s_add_u32 s46, s49, 2367488
  s_add_u32 m0, s24, 106496
  s_nop 0
  buffer_load_dwordx4 v1, s[4:7], s46 offen offset:0 sc1 lds
  s_waitcnt vmcnt(9)
  ds_read_b64_tr_b16 v[128:129], v28 offset:0
  ds_read_b64_tr_b16 v[130:131], v28 offset:1024
  ds_read_b64_tr_b16 v[132:133], v28 offset:64
  ds_read_b64_tr_b16 v[134:135], v28 offset:1088
  ds_read_b64_tr_b16 v[136:137], v28 offset:2048
  ds_read_b64_tr_b16 v[138:139], v28 offset:3072
  ds_read_b64_tr_b16 v[140:141], v28 offset:2112
  ds_read_b64_tr_b16 v[142:143], v28 offset:3136
  ds_read_b64_tr_b16 v[144:145], v28 offset:4096
  ds_read_b64_tr_b16 v[146:147], v28 offset:5120
  ds_read_b64_tr_b16 v[148:149], v28 offset:4160
  ds_read_b64_tr_b16 v[150:151], v28 offset:5184
  ds_read_b64_tr_b16 v[152:153], v28 offset:6144
  ds_read_b64_tr_b16 v[154:155], v28 offset:7168
  ds_read_b64_tr_b16 v[156:157], v28 offset:6208
  ds_read_b64_tr_b16 v[158:159], v28 offset:7232
  ds_read_b64_tr_b16 v[160:161], v28 offset:32768
  ds_read_b64_tr_b16 v[162:163], v28 offset:33792
  ds_read_b64_tr_b16 v[164:165], v28 offset:32832
  ds_read_b64_tr_b16 v[166:167], v28 offset:33856
  ds_read_b64_tr_b16 v[168:169], v28 offset:34816
  ds_read_b64_tr_b16 v[170:171], v28 offset:35840
  ds_read_b64_tr_b16 v[172:173], v28 offset:34880
  ds_read_b64_tr_b16 v[174:175], v28 offset:35904
  ds_read_b64_tr_b16 v[176:177], v28 offset:36864
  ds_read_b64_tr_b16 v[178:179], v28 offset:37888
  ds_read_b64_tr_b16 v[180:181], v28 offset:36928
  ds_read_b64_tr_b16 v[182:183], v28 offset:37952
  ds_read_b64_tr_b16 v[184:185], v28 offset:38912
  ds_read_b64_tr_b16 v[186:187], v28 offset:39936
  ds_read_b64_tr_b16 v[188:189], v28 offset:38976
  ds_read_b64_tr_b16 v[190:191], v28 offset:40000
  s_mov_b32 s50, 0
PL14:
  s_waitcnt lgkmcnt(0)
  s_min_u32 s60, s60, s61
  s_cmp_ge_u32 s60, 16
  s_cbranch_scc1 PD15
  s_mov_b32 s60, 0
  s_mov_b32 s61, 0
  s_atomic_add s60, s[12:13], s53 glc
  s_atomic_add s61, s[12:13], s54 glc
  s_add_u32 s50, s50, 1
  s_cmp_lt_u32 s50, 20000
  s_cbranch_scc1 PL14
  s_waitcnt lgkmcnt(0)
PD15:
  s_add_u32 s49, s36, s22
  s_add_u32 s48, s49, 3145728
  buffer_load_dwordx4 v[192:195], v1, s[4:7], s48 offen offset:0 sc1
  buffer_load_dwordx4 v[196:199], v1, s[4:7], s48 offen offset:1024 sc1
  buffer_load_dwordx4 v[200:203], v1, s[4:7], s48 offen offset:2048 sc1
  buffer_load_dwordx4 v[204:207], v1, s[4:7], s48 offen offset:3072 sc1
  s_add_u32 s48, s49, 3149824
  buffer_load_dwordx4 v[208:211], v1, s[4:7], s48 offen offset:0 sc1
  buffer_load_dwordx4 v[212:215], v1, s[4:7], s48 offen offset:1024 sc1
  buffer_load_dwordx4 v[216:219], v1, s[4:7], s48 offen offset:2048 sc1
  buffer_load_dwordx4 v[220:223], v1, s[4:7], s48 offen offset:3072 sc1
  s_waitcnt vmcnt(8)
  ds_read_b128 v[64:67], v8 offset:0
  ds_read_b128 v[68:71], v8 offset:16
  ds_read_b128 v[72:75], v8 offset:1088
  ds_read_b128 v[76:79], v8 offset:1104
  ds_read_b128 v[80:83], v8 offset:2176
  ds_read_b128 v[84:87], v8 offset:2192
  ds_read_b128 v[88:91], v8 offset:3264
  ds_read_b128 v[92:95], v8 offset:3280
  ds_read_b128 v[96:99], v8 offset:4352
  ds_read_b128 v[100:103], v8 offset:4368
  ds_read_b128 v[104:107], v8 offset:5440
  ds_read_b128 v[108:111], v8 offset:5456
  ds_read_b128 v[112:115], v8 offset:6528
  ds_read_b128 v[116:119], v8 offset:6544
  ds_read_b128 v[120:123], v8 offset:7616
  ds_read_b128 v[124:127], v8 offset:7632
  s_waitcnt lgkmcnt(14)
  v_cvt_pk_bf16_f32 v32, v64, v65
  v_cvt_pk_bf16_f32 v33, v66, v67
  v_cvt_pk_bf16_f32 v34, v68, v69
  v_cvt_pk_bf16_f32 v35, v70, v71
  s_waitcnt lgkmcnt(12)
  v_cvt_pk_bf16_f32 v36, v72, v73
  v_cvt_pk_bf16_f32 v37, v74, v75
  v_cvt_pk_bf16_f32 v38, v76, v77
  v_cvt_pk_bf16_f32 v39, v78, v79
  s_waitcnt lgkmcnt(10)
  v_cvt_pk_bf16_f32 v40, v80, v81
  v_cvt_pk_bf16_f32 v41, v82, v83
  v_cvt_pk_bf16_f32 v42, v84, v85
  v_cvt_pk_bf16_f32 v43, v86, v87
  s_waitcnt lgkmcnt(8)
  v_cvt_pk_bf16_f32 v44, v88, v89
  v_cvt_pk_bf16_f32 v45, v90, v91
  v_cvt_pk_bf16_f32 v46, v92, v93
  v_cvt_pk_bf16_f32 v47, v94, v95
  s_waitcnt lgkmcnt(6)
  v_cvt_pk_bf16_f32 v48, v96, v97
  v_cvt_pk_bf16_f32 v49, v98, v99
  v_cvt_pk_bf16_f32 v50, v100, v101
  v_cvt_pk_bf16_f32 v51, v102, v103
  s_waitcnt lgkmcnt(4)
  v_cvt_pk_bf16_f32 v52, v104, v105
  v_cvt_pk_bf16_f32 v53, v106, v107
  v_cvt_pk_bf16_f32 v54, v108, v109
  v_cvt_pk_bf16_f32 v55, v110, v111
  s_waitcnt lgkmcnt(2)
  v_cvt_pk_bf16_f32 v56, v112, v113
  v_cvt_pk_bf16_f32 v57, v114, v115
  v_cvt_pk_bf16_f32 v58, v116, v117
  v_cvt_pk_bf16_f32 v59, v118, v119
  s_waitcnt lgkmcnt(0)
  v_cvt_pk_bf16_f32 v60, v120, v121
  v_cvt_pk_bf16_f32 v61, v122, v123
  v_cvt_pk_bf16_f32 v62, v124, v125
  v_cvt_pk_bf16_f32 v63, v126, v127
  s_add_u32 s48, s49, 3178496
  buffer_load_dwordx4 v[224:227], v1, s[4:7], s48 offen offset:0 sc1
  buffer_load_dwordx4 v[228:231], v1, s[4:7], s48 offen offset:1024 sc1
  buffer_load_dwordx4 v[232:235], v1, s[4:7], s48 offen offset:2048 sc1
  buffer_load_dwordx4 v[236:239], v1, s[4:7], s48 offen offset:3072 sc1
  s_add_u32 s48, s49, 3182592
  buffer_load_dwordx4 v[240:243], v1, s[4:7], s48 offen offset:0 sc1
  buffer_load_dwordx4 v[244:247], v1, s[4:7], s48 offen offset:1024 sc1
  buffer_load_dwordx4 v[248:251], v1, s[4:7], s48 offen offset:2048 sc1
  buffer_load_dwordx4 v[252:255], v1, s[4:7], s48 offen offset:3072 sc1
  s_waitcnt vmcnt(15)
  v_mfma_f32_32x32x16_bf16 v[96:111], v[32:35], v[192:195], 0
  s_waitcnt vmcnt(14)
  v_mfma_f32_32x32x16_bf16 v[112:127], v[36:39], v[196:199], 0
  s_nop 9
  v_add_f32 v104, s32, v104
  v_rcp_f32 v104, v104
  s_nop 0
  v_mul_f32 v96, v96, v104
  v_mul_f32_e64 v97, v97, v104
  v_cvt_pk_bf16_f32 v192, v96, v97
  v_mul_f32 v98, v98, v104
  v_mul_f32 v99, v99, v104
  v_cvt_pk_bf16_f32 v193, v98, v99
  v_mul_f32 v100, v100, v104
  v_mul_f32 v101, v101, v104
  v_cvt_pk_bf16_f32 v194, v100, v101
  v_mul_f32 v102, v102, v104
  v_mul_f32 v103, v103, v104
  v_cvt_pk_bf16_f32 v195, v102, v103
  s_waitcnt vmcnt(13)
  v_mfma_f32_32x32x16_bf16 v[96:111], v[40:43], v[200:203], 0
  v_add_f32 v120, s32, v120
  v_rcp_f32 v120, v120
  s_nop 0
  v_mul_f32 v112, v112, v120
  v_mul_f32 v113, v113, v120
  v_mfma_f32_32x32x16_bf16 v[64:79], v[128:131], v[192:195], 0
  v_cvt_pk_bf16_f32 v196, v112, v113
  v_mul_f32 v114, v114, v120
  v_mul_f32 v115, v115, v120
  v_cvt_pk_bf16_f32 v197, v114, v115
  v_mul_f32_e64 v116, v116, v120
  v_mfma_f32_32x32x16_bf16 v[80:95], v[132:135], v[192:195], 0
  v_mul_f32_e64 v117, v117, v120
  v_cvt_pk_bf16_f32 v198, v116, v117
  v_mul_f32 v118, v118, v120
  v_mul_f32 v119, v119, v120
  v_cvt_pk_bf16_f32 v199, v118, v119
  s_waitcnt vmcnt(12)
  v_mfma_f32_32x32x16_bf16 v[112:127], v[44:47], v[204:207], 0
  v_add_f32 v104, s32, v104
  v_rcp_f32 v104, v104
  s_nop 0
  v_mul_f32 v96, v96, v104
  v_mul_f32 v97, v97, v104
  v_mfma_f32_32x32x16_bf16 v[64:79], v[136:139], v[196:199], v[64:79]
  v_cvt_pk_bf16_f32 v200, v96, v97
  v_mul_f32 v98, v98, v104
  v_mul_f32 v99, v99, v104
  v_cvt_pk_bf16_f32 v201, v98, v99
  v_mul_f32_e64 v100, v100, v104
  v_mfma_f32_32x32x16_bf16 v[80:95], v[140:143], v[196:199], v[80:95]
  v_mul_f32_e64 v101, v101, v104
  v_cvt_pk_bf16_f32 v202, v100, v101
  v_mul_f32 v102, v102, v104
  v_mul_f32 v103, v103, v104
  v_cvt_pk_bf16_f32 v203, v102, v103
  s_waitcnt vmcnt(11)
  v_mfma_f32_32x32x16_bf16 v[96:111], v[48:51], v[208:211], 0
  v_add_f32 v120, s32, v120
  v_rcp_f32 v120, v120
  s_nop 0
  v_mul_f32 v112, v112, v120
  v_mul_f32 v113, v113, v120
  v_mfma_f32_32x32x16_bf16 v[64:79], v[144:147], v[200:203], v[64:79]
  v_cvt_pk_bf16_f32 v204, v112, v113
  v_mul_f32 v114, v114, v120
  v_mul_f32 v115, v115, v120
  v_cvt_pk_bf16_f32 v205, v114, v115
  v_mul_f32_e64 v116, v116, v120
  v_mfma_f32_32x32x16_bf16 v[80:95], v[148:151], v[200:203], v[80:95]
  v_mul_f32_e64 v117, v117, v120
  v_cvt_pk_bf16_f32 v206, v116, v117
  v_mul_f32 v118, v118, v120
  v_mul_f32 v119, v119, v120
  v_cvt_pk_bf16_f32 v207, v118, v119
  s_waitcnt vmcnt(10)
  v_mfma_f32_32x32x16_bf16 v[112:127], v[52:55], v[212:215], 0
  s_barrier
  v_add_f32 v104, s32, v104
  v_rcp_f32 v104, v104
  s_nop 0
  v_mul_f32 v96, v96, v104
  v_mul_f32_e64 v97, v97, v104
  v_mfma_f32_32x32x16_bf16 v[64:79], v[152:155], v[204:207], v[64:79]
  v_cvt_pk_bf16_f32 v208, v96, v97
  v_mul_f32 v98, v98, v104
  v_mul_f32 v99, v99, v104
  v_cvt_pk_bf16_f32 v209, v98, v99
  v_mul_f32_e64 v100, v100, v104
  v_mfma_f32_32x32x16_bf16 v[80:95], v[156:159], v[204:207], v[80:95]
  v_mul_f32_e64 v101, v101, v104
  v_cvt_pk_bf16_f32 v210, v100, v101
  v_mul_f32 v102, v102, v104
  v_mul_f32 v103, v103, v104
  v_cvt_pk_bf16_f32 v211, v102, v103
  s_waitcnt vmcnt(9)
  v_mfma_f32_32x32x16_bf16 v[96:111], v[56:59], v[216:219], 0
  s_add_u32 s46, s28, 32768
  s_add_u32 m0, s22, 0
  s_nop 0
  buffer_load_dwordx4 v1, s[4:7], s46 offen offset:0 sc1 lds
  v_add_f32 v120, s32, v120
  v_rcp_f32 v120, v120
  s_nop 0
  v_mul_f32 v112, v112, v120
  v_mul_f32 v113, v113, v120
  v_mfma_f32_32x32x16_bf16 v[64:79], v[160:163], v[208:211], v[64:79]
  v_cvt_pk_bf16_f32 v212, v112, v113
  v_mul_f32 v114, v114, v120
  v_mul_f32 v115, v115, v120
  v_cvt_pk_bf16_f32 v213, v114, v115
  v_mul_f32_e64 v116, v116, v120
  v_mfma_f32_32x32x16_bf16 v[80:95], v[164:167], v[208:211], v[80:95]
  s_cbranch_vccz L16
  s_add_u32 m0, s22, 65536
  s_nop 0
  buffer_load_dwordx4 v1, s[4:7], s28 offen offset:0 sc1 lds
L16:
  v_mul_f32_e64 v117, v117, v120
  v_cvt_pk_bf16_f32 v214, v116, v117
  v_mul_f32 v118, v118, v120
  v_mul_f32 v119, v119, v120
  v_cvt_pk_bf16_f32 v215, v118, v119
  s_waitcnt vmcnt(10)
  s_cbranch_vccnz W1
  s_waitcnt vmcnt(9)
W1:
  v_mfma_f32_32x32x16_bf16 v[112:127], v[60:63], v[220:223], 0
  s_add_u32 s46, s28, 32768
  s_add_u32 m0, s22, 0
  s_nop 0
  buffer_load_dwordx4 v1, s[4:7], s46 offen offset:1024 sc1 lds
  v_add_f32 v104, s32, v104
  v_rcp_f32 v104, v104
  s_nop 0
  v_mul_f32 v96, v96, v104
  v_mul_f32 v97, v97, v104
  v_mfma_f32_32x32x16_bf16 v[64:79], v[168:171], v[212:215], v[64:79]
  v_cvt_pk_bf16_f32 v216, v96, v97
  v_mul_f32 v98, v98, v104
  v_mul_f32 v99, v99, v104
  v_cvt_pk_bf16_f32 v217, v98, v99
  v_mul_f32_e64 v100, v100, v104
  v_mfma_f32_32x32x16_bf16 v[80:95], v[172:175], v[212:215], v[80:95]
  s_cbranch_vccz L17
  s_add_u32 m0, s22, 65536
  s_nop 0
  buffer_load_dwordx4 v1, s[4:7], s28 offen offset:1024 sc1 lds
L17:
  v_mul_f32_e64 v101, v101, v104
  v_cvt_pk_bf16_f32 v218, v100, v101
  v_mul_f32 v102, v102, v104
  v_mul_f32 v103, v103, v104
  v_cvt_pk_bf16_f32 v219, v102, v103
  s_waitcnt vmcnt(11)
  s_cbranch_vccnz W2
  s_waitcnt vmcnt(9)
W2:
  v_mfma_f32_32x32x16_bf16 v[96:111], v[32:35], v[224:227], 0
  s_add_u32 s46, s28, 32768
  s_add_u32 m0, s22, 0
  s_nop 0
  buffer_load_dwordx4 v1, s[4:7], s46 offen offset:2048 sc1 lds
  v_add_f32 v120, s32, v120
  v_rcp_f32 v120, v120
  s_nop 0
  v_mul_f32 v112, v112, v120
  v_mul_f32 v113, v113, v120
  v_mfma_f32_32x32x16_bf16 v[64:79], v[176:179], v[216:219], v[64:79]
  v_cvt_pk_bf16_f32 v220, v112, v113
  v_mul_f32 v114, v114, v120
  v_mul_f32 v115, v115, v120
  v_cvt_pk_bf16_f32 v221, v114, v115
  v_mul_f32_e64 v116, v116, v120
  v_mfma_f32_32x32x16_bf16 v[80:95], v[180:183], v[216:219], v[80:95]
  s_cbranch_vccz L18
  s_add_u32 m0, s22, 65536
  s_nop 0
  buffer_load_dwordx4 v1, s[4:7], s28 offen offset:2048 sc1 lds
L18:
  v_mul_f32_e64 v117, v117, v120
  v_cvt_pk_bf16_f32 v222, v116, v117
  v_mul_f32 v118, v118, v120
  v_mul_f32 v119, v119, v120
  v_cvt_pk_bf16_f32 v223, v118, v119
  s_waitcnt vmcnt(12)
  s_cbranch_vccnz W3
  s_waitcnt vmcnt(9)
W3:
  v_mfma_f32_32x32x16_bf16 v[112:127], v[36:39], v[228:231], 0
  s_add_u32 s46, s28, 32768
  s_add_u32 m0, s22, 0
  s_nop 0
  buffer_load_dwordx4 v1, s[4:7], s46 offen offset:3072 sc1 lds
  v_add_f32 v104, s32, v104
  v_rcp_f32 v104, v104
  s_nop 0
  v_mul_f32 v96, v96, v104
  v_mul_f32 v97, v97, v104
  v_mfma_f32_32x32x16_bf16 v[64:79], v[184:187], v[220:223], v[64:79]
  v_cvt_pk_bf16_f32 v224, v96, v97
  v_mul_f32 v98, v98, v104
  v_mul_f32 v99, v99, v104
  v_cvt_pk_bf16_f32 v225, v98, v99
  v_mul_f32_e64 v100, v100, v104
  v_mfma_f32_32x32x16_bf16 v[80:95], v[188:191], v[220:223], v[80:95]
  s_cbranch_vccz L19
  s_add_u32 m0, s22, 65536
  s_nop 0
  buffer_load_dwordx4 v1, s[4:7], s28 offen offset:3072 sc1 lds
L19:
  v_mul_f32_e64 v101, v101, v104
  v_cvt_pk_bf16_f32 v226, v100, v101
  v_mul_f32 v102, v102, v104
  v_mul_f32 v103, v103, v104
  v_cvt_pk_bf16_f32 v227, v102, v103
  s_waitcnt vmcnt(13)
  s_cbranch_vccnz W4
  s_waitcnt vmcnt(9)
W4:
  v_mfma_f32_32x32x16_bf16 v[96:111], v[40:43], v[232:235], 0
  s_add_u32 s46, s28, 36864
  s_add_u32 m0, s22, 4096
  s_nop 0
  buffer_load_dwordx4 v1, s[4:7], s46 offen offset:0 sc1 lds
  v_add_f32 v120, s32, v120
  v_rcp_f32 v120, v120
  s_nop 0
  v_mul_f32 v112, v112, v120
  v_mul_f32_e64 v113, v113, v120
  v_mfma_f32_32x32x16_bf16 v[192:207], v[128:131], v[224:227], 0
  v_cvt_pk_bf16_f32 v228, v112, v113
  v_mul_f32 v114, v114, v120
  v_mul_f32 v115, v115, v120
  v_cvt_pk_bf16_f32 v229, v114, v115
  v_mul_f32_e64 v116, v116, v120
  v_mfma_f32_32x32x16_bf16 v[208:223], v[132:135], v[224:227], 0
  s_cbranch_vccz L20
  s_add_u32 s46, s28, 4096
  s_add_u32 m0, s22, 69632
  s_nop 0
  buffer_load_dwordx4 v1, s[4:7], s46 offen offset:0 sc1 lds
L20:
  v_mul_f32_e64 v117, v117, v120
  v_cvt_pk_bf16_f32 v230, v116, v117
  v_mul_f32 v118, v118, v120
  v_mul_f32 v119, v119, v120
  v_cvt_pk_bf16_f32 v231, v118, v119
  s_waitcnt vmcnt(14)
  s_cbranch_vccnz W5
  s_waitcnt vmcnt(9)
W5:
  v_mfma_f32_32x32x16_bf16 v[112:127], v[44:47], v[236:239], 0
  s_add_u32 s46, s28, 36864
  s_add_u32 m0, s22, 4096
  s_nop 0
  buffer_load_dwordx4 v1, s[4:7], s46 offen offset:1024 sc1 lds
  v_add_f32 v104, s32, v104
  v_rcp_f32 v104, v104
  s_nop 0
  v_mul_f32 v96, v96, v104
  v_mul_f32_e64 v97, v97, v104
  s_add_u32 s44, s24, 98304
  v_add_u32_e64 v28, s44, v1
  v_mfma_f32_32x32x16_bf16 v[192:207], v[136:139], v[228:231], v[192:207]
  v_cvt_pk_bf16_f32 v232, v96, v97
  v_mul_f32 v98, v98, v104
  v_mul_f32 v99, v99, v104
  v_cvt_pk_bf16_f32 v233, v98, v99
  v_mul_f32_e64 v100, v100, v104
  v_mfma_f32_32x32x16_bf16 v[208:223], v[140:143], v[228:231], v[208:223]
  s_cbranch_vccz L21
  s_add_u32 s46, s28, 4096
  s_add_u32 m0, s22, 69632
  s_nop 0
  buffer_load_dwordx4 v1, s[4:7], s46 offen offset:1024 sc1 lds
L21:
  v_mul_f32_e64 v101, v101, v104
  v_cvt_pk_bf16_f32 v234, v100, v101
  v_mul_f32 v102, v102, v104
  v_mul_f32 v103, v103, v104
  v_cvt_pk_bf16_f32 v235, v102, v103
  v_xor_b32 v29, 0x80, v28
  s_waitcnt vmcnt(15)
  s_cbranch_vccnz W6
  s_waitcnt vmcnt(9)
W6:
  v_mfma_f32_32x32x16_bf16 v[96:111], v[48:51], v[240:243], 0
  s_add_u32 s46, s28, 36864
  s_add_u32 m0, s22, 4096
  s_nop 0
  buffer_load_dwordx4 v1, s[4:7], s46 offen offset:2048 sc1 lds
  v_add_f32 v120, s32, v120
  v_rcp_f32 v120, v120
  s_nop 0
  v_mul_f32 v112, v112, v120
  v_mul_f32_e64 v113, v113, v120
  ds_write_b128 v28, v[64:67] offset:0
  v_mfma_f32_32x32x16_bf16 v[192:207], v[144:147], v[232:235], v[192:207]
  v_cvt_pk_bf16_f32 v236, v112, v113
  v_mul_f32 v114, v114, v120
  v_mul_f32 v115, v115, v120
  v_cvt_pk_bf16_f32 v237, v114, v115
  v_mul_f32_e64 v116, v116, v120
  ds_write_b128 v28, v[68:71] offset:1024
  v_mfma_f32_32x32x16_bf16 v[208:223], v[148:151], v[232:235], v[208:223]
  s_cbranch_vccz L22
  s_add_u32 s46, s28, 4096
  s_add_u32 m0, s22, 69632
  s_nop 0
  buffer_load_dwordx4 v1, s[4:7], s46 offen offset:2048 sc1 lds
L22:
  v_mul_f32_e64 v117, v117, v120
  v_cvt_pk_bf16_f32 v238, v116, v117
  v_mul_f32 v118, v118, v120
  v_mul_f32 v119, v119, v120
  v_cvt_pk_bf16_f32 v239, v118, v119
  ds_write_b128 v28, v[72:75] offset:2048
  s_waitcnt vmcnt(16)
  s_cbranch_vccnz W7
  s_waitcnt vmcnt(9)
W7:
  v_mfma_f32_32x32x16_bf16 v[112:127], v[52:55], v[244:247], 0
  s_add_u32 s46, s28, 36864
  s_add_u32 m0, s22, 4096
  s_nop 0
  buffer_load_dwordx4 v1, s[4:7], s46 offen offset:3072 sc1 lds
  v_add_f32 v104, s32, v104
  v_rcp_f32 v104, v104
  s_nop 0
  v_mul_f32 v96, v96, v104
  v_mul_f32_e64 v97, v97, v104
  ds_write_b128 v28, v[76:79] offset:3072
  v_mfma_f32_32x32x16_bf16 v[192:207], v[152:155], v[236:239], v[192:207]
  v_cvt_pk_bf16_f32 v240, v96, v97
  v_mul_f32 v98, v98, v104
  v_mul_f32 v99, v99, v104
  v_cvt_pk_bf16_f32 v241, v98, v99
  v_mul_f32_e64 v100, v100, v104
  ds_write_b128 v29, v[80:83] offset:4096
  v_mfma_f32_32x32x16_bf16 v[208:223], v[156:159], v[236:239], v[208:223]
  s_cbranch_vccz L23
  s_add_u32 s46, s28, 4096
  s_add_u32 m0, s22, 69632
  s_nop 0
  buffer_load_dwordx4 v1, s[4:7], s46 offen offset:3072 sc1 lds
L23:
  v_mul_f32_e64 v101, v101, v104
  v_cvt_pk_bf16_f32 v242, v100, v101
  v_mul_f32 v102, v102, v104
  v_mul_f32 v103, v103, v104
  v_cvt_pk_bf16_f32 v243, v102, v103
  ds_write_b128 v29, v[84:87] offset:5120
  s_waitcnt vmcnt(17)
  s_cbranch_vccnz W8
  s_waitcnt vmcnt(9)
W8:
  v_mfma_f32_32x32x16_bf16 v[96:111], v[56:59], v[248:251], 0
  v_add_f32 v120, s32, v120
  v_rcp_f32 v120, v120
  s_nop 0
  v_mul_f32 v112, v112, v120
  v_mul_f32 v113, v113, v120
  ds_write_b128 v29, v[88:91] offset:6144
  v_mfma_f32_32x32x16_bf16 v[192:207], v[160:163], v[240:243], v[192:207]
  v_cvt_pk_bf16_f32 v244, v112, v113
  v_mul_f32 v114, v114, v120
  v_mul_f32 v115, v115, v120
  v_cvt_pk_bf16_f32 v245, v114, v115
  v_mul_f32_e64 v116, v116, v120
  ds_write_b128 v29, v[92:95] offset:7168
  v_mfma_f32_32x32x16_bf16 v[208:223], v[164:167], v[240:243], v[208:223]
  s_cbranch_vccz L24
  s_add_u32 m0, s31, 139264
  s_nop 0
  buffer_load_dwordx4 v1, s[4:7], s29 offen offset:0 sc1 lds
L24:
  v_mul_f32_e64 v117, v117, v120
  v_cvt_pk_bf16_f32 v246, v116, v117
  v_mul_f32 v118, v118, v120
  v_mul_f32 v119, v119, v120
  v_cvt_pk_bf16_f32 v247, v118, v119
  s_add_u32 s44, s22, 32768
  v_add_u32 v30, s44, v1
  s_waitcnt vmcnt(17)
  s_cbranch_vccnz W9
  s_waitcnt vmcnt(8)
W9:
  v_mfma_f32_32x32x16_bf16 v[112:127], v[60:63], v[252:255], 0
  v_add_f32 v104, s32, v104
  v_rcp_f32 v104, v104
  s_nop 0
  v_mul_f32 v96, v96, v104
  v_mul_f32_e64 v97, v97, v104
  v_mfma_f32_32x32x16_bf16 v[192:207], v[168:171], v[244:247], v[192:207]
  v_cvt_pk_bf16_f32 v248, v96, v97
  v_mul_f32 v98, v98, v104
  v_mul_f32 v99, v99, v104
  v_cvt_pk_bf16_f32 v249, v98, v99
  v_mul_f32_e64 v100, v100, v104
  v_xor_b32 v31, 0x80, v30
  v_mfma_f32_32x32x16_bf16 v[208:223], v[172:175], v[244:247], v[208:223]
  s_cbranch_vccz L25
  s_add_u32 m0, s31, 139264
  s_nop 0
  buffer_load_dwordx4 v1, s[4:7], s29 offen offset:1024 sc1 lds
L25:
  v_mul_f32_e64 v101, v101, v104
  v_cvt_pk_bf16_f32 v250, v100, v101
  v_mul_f32 v102, v102, v104
  v_mul_f32 v103, v103, v104
  v_cvt_pk_bf16_f32 v251, v102, v103
  v_subrev_u32 v27, 32768, v4
  v_add_f32 v120, s32, v120
  v_rcp_f32 v120, v120
  s_nop 0
  v_mul_f32 v112, v112, v120
  v_mul_f32_e64 v113, v113, v120
  v_mfma_f32_32x32x16_bf16 v[192:207], v[176:179], v[248:251], v[192:207]
  v_cvt_pk_bf16_f32 v252, v112, v113
  v_mul_f32 v114, v114, v120
  v_mul_f32 v115, v115, v120
  v_cvt_pk_bf16_f32 v253, v114, v115
  v_mul_f32_e64 v116, v116, v120
  v_mfma_f32_32x32x16_bf16 v[208:223], v[180:183], v[248:251], v[208:223]
  v_mul_f32_e64 v117, v117, v120
  v_cvt_pk_bf16_f32 v254, v116, v117
  v_mul_f32 v118, v118, v120
  v_mul_f32 v119, v119, v120
  v_cvt_pk_bf16_f32 v255, v118, v119
  s_nop 1
  v_mfma_f32_32x32x16_bf16 v[192:207], v[184:187], v[252:255], v[192:207]
  v_mfma_f32_32x32x16_bf16 v[208:223], v[188:191], v[252:255], v[208:223]
  s_nop 10
  ds_write_b128 v30, v[192:195] offset:0
  ds_write_b128 v30, v[196:199] offset:1024
  ds_write_b128 v30, v[200:203] offset:2048
  ds_write_b128 v30, v[204:207] offset:3072
  ds_write_b128 v31, v[208:211] offset:4096
  ds_write_b128 v31, v[212:215] offset:5120
  ds_write_b128 v31, v[216:219] offset:6144
  ds_write_b128 v31, v[220:223] offset:7168
  v_mov_b32_e64 v32, v27
  v_accvgpr_read_b32 v16, a224
  v_accvgpr_read_b32 v17, a225
  v_accvgpr_read_b32 v18, a226
  v_accvgpr_read_b32 v19, a227
  v_accvgpr_read_b32 v20, a228
  v_accvgpr_read_b32 v21, a229
  v_accvgpr_read_b32 v22, a230
  v_accvgpr_read_b32 v23, a231
  v_accvgpr_read_b32 v24, a232
  v_accvgpr_read_b32 v25, a233
  v_accvgpr_read_b32 v26, a234
  v_accvgpr_read_b32 v27, a235
  v_accvgpr_read_b32 v28, a236
  v_accvgpr_read_b32 v29, a237
  v_accvgpr_read_b32 v30, a238
  v_accvgpr_read_b32 v31, a239
  s_waitcnt lgkmcnt(0)
  s_barrier
  ds_read_b128 v[64:67], v4 offset:32768
  ds_read_b128 v[68:71], v4 offset:33792
  ds_read_b128 v[72:75], v4 offset:41984
  ds_read_b128 v[76:79], v4 offset:43008
  ds_read_b128 v[80:83], v4 offset:51200
  ds_read_b128 v[84:87], v4 offset:52224
  ds_read_b128 v[88:91], v4 offset:60416
  ds_read_b128 v[92:95], v4 offset:61440
  ds_read_b128 v[96:99], v32 offset:0
  ds_read_b128 v[100:103], v32 offset:1024
  ds_read_b128 v[104:107], v32 offset:8192
  ds_read_b128 v[108:111], v32 offset:9216
  ds_read_b128 v[112:115], v32 offset:16384
  ds_read_b128 v[116:119], v32 offset:17408
  ds_read_b128 v[120:123], v32 offset:24576
  ds_read_b128 v[124:127], v32 offset:25600
  s_waitcnt lgkmcnt(14)
  v_pk_add_f32 v[16:17], v[16:17], v[64:65]
  v_pk_add_f32 v[18:19], v[18:19], v[66:67]
  v_pk_add_f32 v[20:21], v[20:21], v[68:69]
  v_pk_add_f32 v[22:23], v[22:23], v[70:71]
  s_waitcnt lgkmcnt(12)
  v_pk_add_f32 v[16:17], v[16:17], v[72:73]
  v_pk_add_f32 v[18:19], v[18:19], v[74:75]
  v_pk_add_f32 v[20:21], v[20:21], v[76:77]
  v_pk_add_f32 v[22:23], v[22:23], v[78:79]
  s_waitcnt lgkmcnt(10)
  v_pk_add_f32 v[16:17], v[16:17], v[80:81]
  v_pk_add_f32 v[18:19], v[18:19], v[82:83]
  v_pk_add_f32 v[20:21], v[20:21], v[84:85]
  v_pk_add_f32 v[22:23], v[22:23], v[86:87]
  s_waitcnt lgkmcnt(8)
  v_pk_add_f32 v[16:17], v[16:17], v[88:89]
  v_pk_add_f32 v[18:19], v[18:19], v[90:91]
  v_pk_add_f32 v[20:21], v[20:21], v[92:93]
  v_pk_add_f32 v[22:23], v[22:23], v[94:95]
  v_cvt_pk_bf16_f32 v72, v16, v17
  v_cvt_pk_bf16_f32 v73, v18, v19
  v_cvt_pk_bf16_f32 v74, v20, v21
  v_cvt_pk_bf16_f32 v75, v22, v23
  s_add_u32 s44, s37, 5242880
  buffer_store_dwordx4 v[72:75], v5, s[4:7], s44 offen sc0 sc1
  s_waitcnt lgkmcnt(6)
  v_pk_add_f32 v[24:25], v[24:25], v[96:97]
  v_pk_add_f32 v[26:27], v[26:27], v[98:99]
  v_pk_add_f32 v[28:29], v[28:29], v[100:101]
  v_pk_add_f32 v[30:31], v[30:31], v[102:103]
  s_waitcnt lgkmcnt(4)
  v_pk_add_f32 v[24:25], v[24:25], v[104:105]
  v_pk_add_f32 v[26:27], v[26:27], v[106:107]
  v_pk_add_f32 v[28:29], v[28:29], v[108:109]
  v_pk_add_f32 v[30:31], v[30:31], v[110:111]
  s_waitcnt lgkmcnt(2)
  v_pk_add_f32 v[24:25], v[24:25], v[112:113]
  v_pk_add_f32 v[26:27], v[26:27], v[114:115]
  v_pk_add_f32 v[28:29], v[28:29], v[116:117]
  v_pk_add_f32 v[30:31], v[30:31], v[118:119]
  s_waitcnt lgkmcnt(0)
  v_pk_add_f32 v[24:25], v[24:25], v[120:121]
  v_pk_add_f32 v[26:27], v[26:27], v[122:123]
  v_pk_add_f32 v[28:29], v[28:29], v[124:125]
  v_pk_add_f32 v[30:31], v[30:31], v[126:127]
  v_cvt_pk_bf16_f32 v104, v24, v25
  v_cvt_pk_bf16_f32 v105, v26, v27
  v_cvt_pk_bf16_f32 v106, v28, v29
  v_cvt_pk_bf16_f32 v107, v30, v31
  s_add_u32 s44, s37, 5275648
  buffer_store_dwordx4 v[104:107], v5, s[4:7], s44 offen sc0 sc1
  v_pk_add_f32 v[64:65], v[16:17], v[18:19]
  v_pk_add_f32 v[96:97], v[24:25], v[26:27]
  v_pk_mul_f32 v[66:67], v[16:17], v[16:17]
  v_pk_mul_f32 v[98:99], v[24:25], v[24:25]
  v_pk_add_f32 v[68:69], v[20:21], v[22:23]
  v_pk_add_f32 v[100:101], v[28:29], v[30:31]
  v_pk_fma_f32 v[66:67], v[18:19], v[18:19], v[66:67]
  v_pk_fma_f32 v[98:99], v[26:27], v[26:27], v[98:99]
  v_pk_add_f32 v[64:65], v[64:65], v[68:69]
  v_pk_add_f32 v[96:97], v[96:97], v[100:101]
  v_pk_fma_f32 v[66:67], v[20:21], v[20:21], v[66:67]
  v_pk_fma_f32 v[98:99], v[28:29], v[28:29], v[98:99]
  v_pk_fma_f32 v[66:67], v[22:23], v[22:23], v[66:67]
  v_pk_fma_f32 v[98:99], v[30:31], v[30:31], v[98:99]
  v_add_f32 v64, v64, v65
  v_add_f32 v96, v96, v97
  v_add_f32 v65, v66, v67
  v_add_f32 v97, v98, v99
  v_add_f32_dpp v64, v64, v64 row_ror:8 row_mask:0xf bank_mask:0xf
  v_add_f32_dpp v96, v96, v96 row_ror:8 row_mask:0xf bank_mask:0xf
  v_add_f32_dpp v65, v65, v65 row_ror:8 row_mask:0xf bank_mask:0xf
  v_add_f32_dpp v97, v97, v97 row_ror:8 row_mask:0xf bank_mask:0xf
  v_mov_b32 v66, v64
  v_mov_b32 v98, v96
  v_mov_b32 v67, v65
  v_mov_b32 v99, v97
  v_permlane16_swap_b32 v64, v66
  v_permlane16_swap_b32 v96, v98
  v_permlane16_swap_b32 v65, v67
  v_permlane16_swap_b32 v97, v99
  v_pk_add_f32 v[64:65], v[64:65], v[66:67]
  v_pk_add_f32 v[96:97], v[96:97], v[98:99]
  v_mov_b32 v66, v64
  v_mov_b32 v98, v96
  v_mov_b32 v67, v65
  v_mov_b32 v99, v97
  v_permlane32_swap_b32 v64, v66
  v_permlane32_swap_b32 v96, v98
  v_permlane32_swap_b32 v65, v67
  v_permlane32_swap_b32 v97, v99
  v_pk_add_f32 v[64:65], v[64:65], v[66:67]
  v_pk_add_f32 v[96:97], v[96:97], v[98:99]
  s_add_u32 s44, s38, 2228224
  s_mov_b64 exec, 0xff
  buffer_store_dwordx2 v[64:65], v6, s[4:7], s44 offen sc0 sc1
  buffer_store_dwordx2 v[96:97], v6, s[4:7], s44 offen offset:2048 sc0 sc1
  s_mov_b64 exec, -1
  v_accvgpr_write_b32 a224, v16
  v_accvgpr_write_b32 a225, v17
  v_accvgpr_write_b32 a226, v18
  v_accvgpr_write_b32 a227, v19
  v_accvgpr_write_b32 a228, v20
  v_accvgpr_write_b32 a229, v21
  v_accvgpr_write_b32 a230, v22
  v_accvgpr_write_b32 a231, v23
  v_accvgpr_write_b32 a232, v24
  v_accvgpr_write_b32 a233, v25
  v_accvgpr_write_b32 a234, v26
  v_accvgpr_write_b32 a235, v27
  v_accvgpr_write_b32 a236, v28
  v_accvgpr_write_b32 a237, v29
  v_accvgpr_write_b32 a238, v30
  v_accvgpr_write_b32 a239, v31
  s_waitcnt vmcnt(0)
  s_barrier
  s_cmp_ge_u32 s14, 2
  s_cbranch_scc1 L26
  s_lshl_b32 s44, s19, 1
  s_add_u32 s44, s44, s14
  s_lshl_b32 s44, s44, 7
  s_add_u32 s44, s44, 16384
  s_mov_b32 s52, 1
  s_atomic_add s52, s[12:13], s44
L26:
  s_add_u32 s46, s28, 65536
  s_add_u32 m0, s22, 32768
  s_nop 0
  buffer_load_dwordx4 v1, s[4:7], s46 offen offset:0 sc1 lds
  buffer_load_dwordx4 v1, s[4:7], s46 offen offset:1024 sc1 lds
  buffer_load_dwordx4 v1, s[4:7], s46 offen offset:2048 sc1 lds
  buffer_load_dwordx4 v1, s[4:7], s46 offen offset:3072 sc1 lds
  s_add_u32 s46, s28, 69632
  s_add_u32 m0, s22, 36864
  s_nop 0
  buffer_load_dwordx4 v1, s[4:7], s46 offen offset:0 sc1 lds
  buffer_load_dwordx4 v1, s[4:7], s46 offen offset:1024 sc1 lds
  buffer_load_dwordx4 v1, s[4:7], s46 offen offset:2048 sc1 lds
  buffer_load_dwordx4 v1, s[4:7], s46 offen offset:3072 sc1 lds
  s_cbranch_vccz L27
  buffer_load_dwordx4 a[0:3], v1, s[4:7], s30 offen offset:0 sc1
  buffer_load_dwordx4 a[4:7], v1, s[4:7], s30 offen offset:1024 sc1
  buffer_load_dwordx4 a[8:11], v1, s[4:7], s30 offen offset:2048 sc1
  buffer_load_dwordx4 a[12:15], v1, s[4:7], s30 offen offset:3072 sc1
  s_add_u32 s47, s30, 4096
  buffer_load_dwordx4 a[16:19], v1, s[4:7], s47 offen offset:0 sc1
  buffer_load_dwordx4 a[20:23], v1, s[4:7], s47 offen offset:1024 sc1
  buffer_load_dwordx4 a[24:27], v1, s[4:7], s47 offen offset:2048 sc1
  buffer_load_dwordx4 a[28:31], v1, s[4:7], s47 offen offset:3072 sc1
L27:
  s_lshl_b32 s44, s21, 7
  s_add_u32 s44, s44, 16384
  s_mov_b32 s50, 0
PL28:
  s_mov_b32 s51, 0
  s_atomic_add s51, s[12:13], s44 glc
  s_waitcnt lgkmcnt(0)
  s_cmp_ge_u32 s51, 8
  s_cbranch_scc1 PD29
  s_add_u32 s50, s50, 1
  s_cmp_lt_u32 s50, 20000
  s_cbranch_scc1 PL28
PD29:
  s_add_u32 s48, s34, 5242880
  buffer_load_dwordx4 v[128:131], v1, s[4:7], s48 offen offset:0 sc1
  buffer_load_dwordx4 v[132:135], v1, s[4:7], s48 offen offset:1024 sc1
  buffer_load_dwordx4 v[136:139], v1, s[4:7], s48 offen offset:2048 sc1
  buffer_load_dwordx4 v[140:143], v1, s[4:7], s48 offen offset:3072 sc1
  s_add_u32 s48, s34, 5246976
  buffer_load_dwordx4 v[144:147], v1, s[4:7], s48 offen offset:0 sc1
  buffer_load_dwordx4 v[148:151], v1, s[4:7], s48 offen offset:1024 sc1
  buffer_load_dwordx4 v[152:155], v1, s[4:7], s48 offen offset:2048 sc1
  buffer_load_dwordx4 v[156:159], v1, s[4:7], s48 offen offset:3072 sc1
  s_add_u32 s49, s35, 2228224
  buffer_load_dwordx2 v[16:17], v6, s[4:7], s49 offen offset:0 sc1
  buffer_load_dwordx2 v[18:19], v6, s[4:7], s49 offen offset:512 sc1
  buffer_load_dwordx2 v[20:21], v6, s[4:7], s49 offen offset:1024 sc1
  buffer_load_dwordx2 v[22:23], v6, s[4:7], s49 offen offset:1536 sc1
  s_add_u32 s48, s34, 5251072
  buffer_load_dwordx4 v[160:163], v1, s[4:7], s48 offen offset:0 sc1
  buffer_load_dwordx4 v[164:167], v1, s[4:7], s48 offen offset:1024 sc1
  buffer_load_dwordx4 v[168:171], v1, s[4:7], s48 offen offset:2048 sc1
  buffer_load_dwordx4 v[172:175], v1, s[4:7], s48 offen offset:3072 sc1
  ds_read_b128 v[32:35], v2 offset:0
  ds_read_b128 v[36:39], v1 offset:0
  ds_read_b128 v[40:43], v2 offset:1024
  ds_read_b128 v[44:47], v1 offset:1024
  ds_read_b128 v[48:51], v2 offset:2048
  ds_read_b128 v[52:55], v1 offset:2048
  s_waitcnt vmcnt(15) lgkmcnt(5)
  v_mfma_f32_32x32x16_bf16 v[64:79], v[32:35], v[128:131], 0
  ds_read_b128 v[56:59], v2 offset:3072
  s_waitcnt lgkmcnt(5)
  v_mfma_f32_32x32x16_bf16 v[80:95], v[36:39], v[128:131], 0
  ds_read_b128 v[60:63], v1 offset:3072
  s_add_u32 s48, s34, 5255168
  buffer_load_dwordx4 v[176:179], v1, s[4:7], s48 offen offset:0 sc1
  s_waitcnt vmcnt(15) lgkmcnt(5)
  v_mfma_f32_32x32x16_bf16 v[64:79], v[40:43], v[132:135], v[64:79]
  ds_read_b128 v[32:35], v2 offset:4096
  s_waitcnt lgkmcnt(5)
  v_mfma_f32_32x32x16_bf16 v[80:95], v[44:47], v[132:135], v[80:95]
  ds_read_b128 v[36:39], v1 offset:4096
  buffer_load_dwordx4 v[180:183], v1, s[4:7], s48 offen offset:1024 sc1
  s_waitcnt vmcnt(15) lgkmcnt(5)
  v_mfma_f32_32x32x16_bf16 v[64:79], v[48:51], v[136:139], v[64:79]
  ds_read_b128 v[40:43], v2 offset:5120
  s_waitcnt lgkmcnt(5)
  v_mfma_f32_32x32x16_bf16 v[80:95], v[52:55], v[136:139], v[80:95]
  ds_read_b128 v[44:47], v1 offset:5120
  buffer_load_dwordx4 v[184:187], v1, s[4:7], s48 offen offset:2048 sc1
  s_waitcnt vmcnt(15) lgkmcnt(5)
  v_mfma_f32_32x32x16_bf16 v[64:79], v[56:59], v[140:143], v[64:79]
  ds_read_b128 v[48:51], v2 offset:6144
  s_waitcnt lgkmcnt(5)
  v_mfma_f32_32x32x16_bf16 v[80:95], v[60:63], v[140:143], v[80:95]
  ds_read_b128 v[52:55], v1 offset:6144
  buffer_load_dwordx4 v[188:191], v1, s[4:7], s48 offen offset:3072 sc1
  s_waitcnt vmcnt(15) lgkmcnt(5)
  v_mfma_f32_32x32x16_bf16 v[64:79], v[32:35], v[144:147], v[64:79]
  ds_read_b128 v[56:59], v2 offset:7168
  s_waitcnt lgkmcnt(5)
  v_mfma_f32_32x32x16_bf16 v[80:95], v[36:39], v[144:147], v[80:95]
  ds_read_b128 v[60:63], v1 offset:7168
  s_add_u32 s48, s34, 5259264
  buffer_load_dwordx4 v[192:195], v1, s[4:7], s48 offen offset:0 sc1
  s_waitcnt vmcnt(15) lgkmcnt(5)
  v_mfma_f32_32x32x16_bf16 v[64:79], v[40:43], v[148:151], v[64:79]
  ds_read_b128 v[32:35], v2 offset:8192
  s_waitcnt lgkmcnt(5)
  v_mfma_f32_32x32x16_bf16 v[80:95], v[44:47], v[148:151], v[80:95]
  ds_read_b128 v[36:39], v1 offset:8192
  buffer_load_dwordx4 v[196:199], v1, s[4:7], s48 offen offset:1024 sc1
  s_waitcnt vmcnt(15) lgkmcnt(5)
  v_mfma_f32_32x32x16_bf16 v[64:79], v[48:51], v[152:155], v[64:79]
  ds_read_b128 v[40:43], v2 offset:9216
  s_waitcnt lgkmcnt(5)
  v_mfma_f32_32x32x16_bf16 v[80:95], v[52:55], v[152:155], v[80:95]
  ds_read_b128 v[44:47], v1 offset:9216
  buffer_load_dwordx4 v[200:203], v1, s[4:7], s48 offen offset:2048 sc1
  s_waitcnt vmcnt(15) lgkmcnt(5)
  v_mfma_f32_32x32x16_bf16 v[64:79], v[56:59], v[156:159], v[64:79]
  ds_read_b128 v[48:51], v2 offset:10240
  s_waitcnt lgkmcnt(5)
  v_mfma_f32_32x32x16_bf16 v[80:95], v[60:63], v[156:159], v[80:95]
  ds_read_b128 v[52:55], v1 offset:10240
  buffer_load_dwordx4 v[204:207], v1, s[4:7], s48 offen offset:3072 sc1
  s_waitcnt vmcnt(11) lgkmcnt(5)
  v_mfma_f32_32x32x16_bf16 v[64:79], v[32:35], v[160:163], v[64:79]
  ds_read_b128 v[56:59], v2 offset:11264
  s_waitcnt lgkmcnt(5)
  v_mfma_f32_32x32x16_bf16 v[80:95], v[36:39], v[160:163], v[80:95]
  ds_read_b128 v[60:63], v1 offset:11264
  s_add_u32 s48, s34, 5263360
  buffer_load_dwordx4 v[208:211], v1, s[4:7], s48 offen offset:0 sc1
  v_add_f32 v16, v16, v18
  s_waitcnt vmcnt(11) lgkmcnt(5)
  v_mfma_f32_32x32x16_bf16 v[64:79], v[40:43], v[164:167], v[64:79]
  ds_read_b128 v[32:35], v2 offset:12288
  v_add_f32 v17, v17, v19
  s_waitcnt lgkmcnt(5)
  v_mfma_f32_32x32x16_bf16 v[80:95], v[44:47], v[164:167], v[80:95]
  ds_read_b128 v[36:39], v1 offset:12288
  buffer_load_dwordx4 v[212:215], v1, s[4:7], s48 offen offset:1024 sc1
  v_add_f32 v20, v20, v22
  s_waitcnt vmcnt(11) lgkmcnt(5)
  v_mfma_f32_32x32x16_bf16 v[64:79], v[48:51], v[168:171], v[64:79]
  ds_read_b128 v[40:43], v2 offset:13312
  v_add_f32 v21, v21, v23
  s_waitcnt lgkmcnt(5)
  v_mfma_f32_32x32x16_bf16 v[80:95], v[52:55], v[168:171], v[80:95]
  ds_read_b128 v[44:47], v1 offset:13312
  buffer_load_dwordx4 v[216:219], v1, s[4:7], s48 offen offset:2048 sc1
  v_add_f32 v16, v16, v20
  s_waitcnt vmcnt(11) lgkmcnt(5)
  v_mfma_f32_32x32x16_bf16 v[64:79], v[56:59], v[172:175], v[64:79]
  ds_read_b128 v[48:51], v2 offset:14336
  v_add_f32 v17, v17, v21
  s_waitcnt lgkmcnt(5)
  v_mfma_f32_32x32x16_bf16 v[80:95], v[60:63], v[172:175], v[80:95]
  ds_read_b128 v[52:55], v1 offset:14336
  buffer_load_dwordx4 v[220:223], v1, s[4:7], s48 offen offset:3072 sc1
  v_mov_b32 v18, v16
  s_waitcnt vmcnt(11) lgkmcnt(5)
  v_mfma_f32_32x32x16_bf16 v[64:79], v[32:35], v[176:179], v[64:79]
  ds_read_b128 v[56:59], v2 offset:15360
  v_mov_b32 v19, v17
  s_waitcnt lgkmcnt(5)
  v_mfma_f32_32x32x16_bf16 v[80:95], v[36:39], v[176:179], v[80:95]
  ds_read_b128 v[60:63], v1 offset:15360
  s_add_u32 s48, s34, 5267456
  buffer_load_dwordx4 v[224:227], v1, s[4:7], s48 offen offset:0 sc1
  v_permlane32_swap_b32 v16, v18
  s_waitcnt vmcnt(11) lgkmcnt(5)
  v_mfma_f32_32x32x16_bf16 v[64:79], v[40:43], v[180:183], v[64:79]
  ds_read_b128 v[32:35], v2 offset:16384
  v_permlane32_swap_b32 v17, v19
  s_waitcnt lgkmcnt(5)
  v_mfma_f32_32x32x16_bf16 v[80:95], v[44:47], v[180:183], v[80:95]
  ds_read_b128 v[36:39], v1 offset:16384
  buffer_load_dwordx4 v[228:231], v1, s[4:7], s48 offen offset:1024 sc1
  v_add_f32 v16, v16, v18
  s_waitcnt vmcnt(11) lgkmcnt(5)
  v_mfma_f32_32x32x16_bf16 v[64:79], v[48:51], v[184:187], v[64:79]
  ds_read_b128 v[40:43], v2 offset:17408
  v_add_f32 v17, v17, v19
  s_waitcnt lgkmcnt(5)
  v_mfma_f32_32x32x16_bf16 v[80:95], v[52:55], v[184:187], v[80:95]
  ds_read_b128 v[44:47], v1 offset:17408
  buffer_load_dwordx4 v[232:235], v1, s[4:7], s48 offen offset:2048 sc1
  v_mul_f32 v16, 0xbb000000, v16
  s_waitcnt vmcnt(11) lgkmcnt(5)
  v_mfma_f32_32x32x16_bf16 v[64:79], v[56:59], v[188:191], v[64:79]
  ds_read_b128 v[48:51], v2 offset:18432
  v_mul_f32 v17, 0x3b000000, v17
  s_waitcnt lgkmcnt(5)
  v_mfma_f32_32x32x16_bf16 v[80:95], v[60:63], v[188:191], v[80:95]
  ds_read_b128 v[52:55], v1 offset:18432
  buffer_load_dwordx4 v[236:239], v1, s[4:7], s48 offen offset:3072 sc1
  v_fma_f32 v17, -v16, v16, v17
  s_waitcnt vmcnt(11) lgkmcnt(5)
  v_mfma_f32_32x32x16_bf16 v[64:79], v[32:35], v[192:195], v[64:79]
  ds_read_b128 v[56:59], v2 offset:19456
  v_max_f32_e64 v17, 0, v17
  s_waitcnt lgkmcnt(5)
  v_mfma_f32_32x32x16_bf16 v[80:95], v[36:39], v[192:195], v[80:95]
  ds_read_b128 v[60:63], v1 offset:19456
  s_add_u32 s48, s34, 5271552
  buffer_load_dwordx4 v[240:243], v1, s[4:7], s48 offen offset:0 sc1
  v_add_f32 v17, 0x3727c5ac, v17
  s_waitcnt vmcnt(11) lgkmcnt(5)
  v_mfma_f32_32x32x16_bf16 v[64:79], v[40:43], v[196:199], v[64:79]
  ds_read_b128 v[32:35], v2 offset:20480
  v_rsq_f32_e64 v11, v17
  s_waitcnt lgkmcnt(5)
  v_mfma_f32_32x32x16_bf16 v[80:95], v[44:47], v[196:199], v[80:95]
  ds_read_b128 v[36:39], v1 offset:20480
  buffer_load_dwordx4 v[244:247], v1, s[4:7], s48 offen offset:1024 sc1
  v_cvt_pk_bf16_f32 v13, v16, 0
  s_waitcnt vmcnt(11) lgkmcnt(5)
  v_mfma_f32_32x32x16_bf16 v[64:79], v[48:51], v[200:203], v[64:79]
  ds_read_b128 v[40:43], v2 offset:21504
  v_lshlrev_b32_e64 v18, 16, v13
  s_waitcnt lgkmcnt(5)
  v_mfma_f32_32x32x16_bf16 v[80:95], v[52:55], v[200:203], v[80:95]
  ds_read_b128 v[44:47], v1 offset:21504
  buffer_load_dwordx4 v[248:251], v1, s[4:7], s48 offen offset:2048 sc1
  v_sub_f32 v18, v16, v18
  s_waitcnt vmcnt(11) lgkmcnt(5)
  v_mfma_f32_32x32x16_bf16 v[64:79], v[56:59], v[204:207], v[64:79]
  ds_read_b128 v[48:51], v2 offset:22528
  v_cvt_pk_bf16_f32 v12, v16, v18
  s_waitcnt lgkmcnt(5)
  v_mfma_f32_32x32x16_bf16 v[80:95], v[60:63], v[204:207], v[80:95]
  ds_read_b128 v[52:55], v1 offset:22528
  buffer_load_dwordx4 v[252:255], v1, s[4:7], s48 offen offset:3072 sc1
  v_mov_b32_e64 v15, v13
  s_waitcnt vmcnt(11) lgkmcnt(5)
  v_mfma_f32_32x32x16_bf16 v[64:79], v[32:35], v[208:211], v[64:79]
  ds_read_b128 v[56:59], v2 offset:23552
  v_mov_b32 v14, v12
  s_waitcnt lgkmcnt(5)
  v_mfma_f32_32x32x16_bf16 v[80:95], v[36:39], v[208:211], v[80:95]
  ds_read_b128 v[60:63], v1 offset:23552
  s_add_u32 s46, s28, 98304
  s_add_u32 m0, s22, 98304
  s_nop 0
  buffer_load_dwordx4 v1, s[4:7], s46 offen offset:0 sc1 lds
  v_mul_f32_e64 v10, v11, v11
  s_waitcnt vmcnt(11) lgkmcnt(5)
  v_mfma_f32_32x32x16_bf16 v[64:79], v[40:43], v[212:215], v[64:79]
  ds_read_b128 v[32:35], v2 offset:24576
  s_waitcnt lgkmcnt(5)
  v_mfma_f32_32x32x16_bf16 v[80:95], v[44:47], v[212:215], v[80:95]
  ds_read_b128 v[36:39], v1 offset:24576
  buffer_load_dwordx4 v1, s[4:7], s46 offen offset:1024 sc1 lds
  s_waitcnt vmcnt(11) lgkmcnt(5)
  v_mfma_f32_32x32x16_bf16 v[64:79], v[48:51], v[216:219], v[64:79]
  ds_read_b128 v[40:43], v2 offset:25600
  s_waitcnt lgkmcnt(5)
  v_mfma_f32_32x32x16_bf16 v[80:95], v[52:55], v[216:219], v[80:95]
  ds_read_b128 v[44:47], v1 offset:25600
  buffer_load_dwordx4 v1, s[4:7], s46 offen offset:2048 sc1 lds
  s_waitcnt vmcnt(11) lgkmcnt(5)
  v_mfma_f32_32x32x16_bf16 v[64:79], v[56:59], v[220:223], v[64:79]
  ds_read_b128 v[48:51], v2 offset:26624
  s_waitcnt lgkmcnt(5)
  v_mfma_f32_32x32x16_bf16 v[80:95], v[60:63], v[220:223], v[80:95]
  ds_read_b128 v[52:55], v1 offset:26624
  buffer_load_dwordx4 v1, s[4:7], s46 offen offset:3072 sc1 lds
  s_waitcnt vmcnt(11) lgkmcnt(5)
  v_mfma_f32_32x32x16_bf16 v[64:79], v[32:35], v[224:227], v[64:79]
  ds_read_b128 v[56:59], v2 offset:27648
  s_waitcnt lgkmcnt(5)
  v_mfma_f32_32x32x16_bf16 v[80:95], v[36:39], v[224:227], v[80:95]
  ds_read_b128 v[60:63], v1 offset:27648
  s_add_u32 s46, s28, 102400
  s_add_u32 m0, s22, 102400
  s_nop 0
  buffer_load_dwordx4 v1, s[4:7], s46 offen offset:0 sc1 lds
  s_waitcnt vmcnt(11) lgkmcnt(5)
  v_mfma_f32_32x32x16_bf16 v[64:79], v[40:43], v[228:231], v[64:79]
  ds_read_b128 v[32:35], v2 offset:28672
  s_waitcnt lgkmcnt(5)
  v_mfma_f32_32x32x16_bf16 v[80:95], v[44:47], v[228:231], v[80:95]
  ds_read_b128 v[36:39], v1 offset:28672
  buffer_load_dwordx4 v1, s[4:7], s46 offen offset:1024 sc1 lds
  s_waitcnt vmcnt(11) lgkmcnt(5)
  v_mfma_f32_32x32x16_bf16 v[64:79], v[48:51], v[232:235], v[64:79]
  ds_read_b128 v[40:43], v2 offset:29696
  s_waitcnt lgkmcnt(5)
  v_mfma_f32_32x32x16_bf16 v[80:95], v[52:55], v[232:235], v[80:95]
  ds_read_b128 v[44:47], v1 offset:29696
  buffer_load_dwordx4 v1, s[4:7], s46 offen offset:2048 sc1 lds
  s_waitcnt vmcnt(11) lgkmcnt(5)
  v_mfma_f32_32x32x16_bf16 v[64:79], v[56:59], v[236:239], v[64:79]
  ds_read_b128 v[48:51], v2 offset:30720
  s_waitcnt lgkmcnt(5)
  v_mfma_f32_32x32x16_bf16 v[80:95], v[60:63], v[236:239], v[80:95]
  ds_read_b128 v[52:55], v1 offset:30720
  buffer_load_dwordx4 v1, s[4:7], s46 offen offset:3072 sc1 lds
  s_waitcnt vmcnt(11) lgkmcnt(5)
  v_mfma_f32_32x32x16_bf16 v[64:79], v[32:35], v[240:243], v[64:79]
  ds_read_b128 v[56:59], v2 offset:31744
  s_waitcnt lgkmcnt(5)
  v_mfma_f32_32x32x16_bf16 v[80:95], v[36:39], v[240:243], v[80:95]
  ds_read_b128 v[60:63], v1 offset:31744
  s_waitcnt vmcnt(10) lgkmcnt(5)
  v_mfma_f32_32x32x16_bf16 v[64:79], v[40:43], v[244:247], v[64:79]
  ds_read_b128 v[32:35], v3 offset:8192
  s_waitcnt lgkmcnt(5)
  v_mfma_f32_32x32x16_bf16 v[80:95], v[44:47], v[244:247], v[80:95]
  ds_read_b128 v[36:39], v3 offset:9216
  s_waitcnt vmcnt(9) lgkmcnt(5)
  v_mfma_f32_32x32x16_bf16 v[64:79], v[48:51], v[248:251], v[64:79]
  s_waitcnt lgkmcnt(4)
  v_mfma_f32_32x32x16_bf16 v[80:95], v[52:55], v[248:251], v[80:95]
  s_waitcnt lgkmcnt(0)
  s_barrier
  s_waitcnt vmcnt(8)
  v_mfma_f32_32x32x16_bf16 v[64:79], v[56:59], v[252:255], v[64:79]
  ds_read_b128 v[40:43], v1 offset:32768
  ds_read_b128 v[44:47], v1 offset:33792
  ds_read_b128 v[48:51], v1 offset:34816
  v_mfma_f32_32x32x16_bf16 v[80:95], v[60:63], v[252:255], v[80:95]
  ds_read_b128 v[52:55], v1 offset:35840
  v_mfma_f32_32x32x16_bf16 v[64:79], v[32:35], v[12:15], v[64:79]
  ds_read_b128 v[56:59], v1 offset:36864
  v_mfma_f32_32x32x16_bf16 v[80:95], v[36:39], v[12:15], v[80:95]
  ds_read_b128 v[60:63], v1 offset:37888
  s_mul_i32 s49, s21, 114688
  s_add_u32 s49, s49, s16
  s_mul_i32 s44, s18, 7168
  s_add_u32 s49, s49, s44
  s_add_u32 s49, s49, 7340032
  s_lshl_b32 s54, s21, 2
  s_lshr_b32 s44, s18, 2
  s_add_u32 s54, s54, s44
  s_lshl_b32 s54, s54, 7
  s_add_u32 s54, s54, 40960
  s_lshl_b32 s44, s19, 3
  s_add_u32 s44, s44, s14
  s_lshl_b32 s57, s44, 7
  s_add_u32 s57, s57, 40960
  s_add_u32 s55, s57, 512
  s_mul_i32 s56, s19, 229376
  s_add_u32 s56, s56, s16
  s_mul_i32 s44, s14, 28672
  s_add_u32 s56, s56, s44
  s_add_u32 s56, s56, 7340032
  s_waitcnt lgkmcnt(5)
  v_mfma_f32_32x32x16_bf16 v[96:111], v[40:43], v[128:131], 0
  ds_read_b128 v[32:35], v1 offset:38912
  s_waitcnt lgkmcnt(5)
  v_mfma_f32_32x32x16_bf16 v[96:111], v[44:47], v[132:135], v[96:111]
  ds_read_b128 v[36:39], v1 offset:39936
  s_add_u32 s46, s28, 131072
  s_add_u32 m0, s22, 65536
  s_nop 0
  buffer_load_dwordx4 v1, s[4:7], s46 offen offset:0 sc1 lds
  s_waitcnt lgkmcnt(5)
  v_mfma_f32_32x32x16_bf16 v[96:111], v[48:51], v[136:139], v[96:111]
  ds_read_b128 v[40:43], v1 offset:40960
  v_mul_f32 v64, v64, v72
  v_mul_f32 v64, v64, v10
  v_mul_f32 v65, v65, v73
  s_waitcnt lgkmcnt(5)
  v_mfma_f32_32x32x16_bf16 v[96:111], v[52:55], v[140:143], v[96:111]
  ds_read_b128 v[44:47], v1 offset:41984
  v_mul_f32_e64 v65, v65, v10
  v_cvt_pk_bf16_f32 v72, v64, v65
  v_mul_f32_e64 v66, v66, v74
  buffer_load_dwordx4 v1, s[4:7], s46 offen offset:1024 sc1 lds
  s_waitcnt lgkmcnt(5)
  v_mfma_f32_32x32x16_bf16 v[96:111], v[56:59], v[144:147], v[96:111]
  ds_read_b128 v[48:51], v1 offset:43008
  v_mul_f32 v66, v66, v10
  v_mul_f32 v67, v67, v75
  v_mul_f32_e64 v67, v67, v10
  s_waitcnt lgkmcnt(5)
  v_mfma_f32_32x32x16_bf16 v[96:111], v[60:63], v[148:151], v[96:111]
  ds_read_b128 v[52:55], v1 offset:44032
  v_cvt_pk_bf16_f32 v73, v66, v67
  v_mul_f32 v68, v68, v76
  v_mul_f32 v68, v68, v10
  buffer_load_dwordx4 v1, s[4:7], s46 offen offset:2048 sc1 lds
  s_waitcnt lgkmcnt(5)
  v_mfma_f32_32x32x16_bf16 v[96:111], v[32:35], v[152:155], v[96:111]
  ds_read_b128 v[56:59], v1 offset:45056
  v_mul_f32 v69, v69, v77
  v_mul_f32_e64 v69, v69, v10
  v_cvt_pk_bf16_f32 v74, v68, v69
  s_waitcnt lgkmcnt(5)
  v_mfma_f32_32x32x16_bf16 v[96:111], v[36:39], v[156:159], v[96:111]
  ds_read_b128 v[60:63], v1 offset:46080
  v_mul_f32 v70, v70, v78
  v_mul_f32 v70, v70, v10
  v_mul_f32 v71, v71, v79
  buffer_load_dwordx4 v1, s[4:7], s46 offen offset:3072 sc1 lds
  s_waitcnt lgkmcnt(5)
  v_mfma_f32_32x32x16_bf16 v[96:111], v[40:43], v[160:163], v[96:111]
  ds_read_b128 v[32:35], v1 offset:47104
  v_mul_f32 v71, v71, v10
  v_cvt_pk_bf16_f32 v75, v70, v71
  buffer_store_dwordx4 v[72:75], v1, s[4:7], s49 offen offset:0 sc0 sc1
  s_waitcnt lgkmcnt(5)
  v_mfma_f32_32x32x16_bf16 v[96:111], v[44:47], v[164:167], v[96:111]
  ds_read_b128 v[36:39], v1 offset:48128
  v_mul_f32 v80, v80, v88
  v_mul_f32 v80, v80, v10
  v_mul_f32 v81, v81, v89
  s_add_u32 s46, s28, 135168
  s_add_u32 m0, s22, 69632
  s_nop 0
  buffer_load_dwordx4 v1, s[4:7], s46 offen offset:0 sc1 lds
  s_waitcnt lgkmcnt(5)
  v_mfma_f32_32x32x16_bf16 v[96:111], v[48:51], v[168:171], v[96:111]
  ds_read_b128 v[40:43], v1 offset:49152
  v_mul_f32_e64 v81, v81, v10
  v_cvt_pk_bf16_f32 v88, v80, v81
  v_mul_f32 v82, v82, v90
  s_waitcnt lgkmcnt(5)
  v_mfma_f32_32x32x16_bf16 v[96:111], v[52:55], v[172:175], v[96:111]
  ds_read_b128 v[44:47], v1 offset:50176
  v_mul_f32 v82, v82, v10
  v_mul_f32 v83, v83, v91
  v_mul_f32_e64 v83, v83, v10
  buffer_load_dwordx4 v1, s[4:7], s46 offen offset:1024 sc1 lds
  s_waitcnt lgkmcnt(5)
  v_mfma_f32_32x32x16_bf16 v[96:111], v[56:59], v[176:179], v[96:111]
  ds_read_b128 v[48:51], v1 offset:51200
  v_cvt_pk_bf16_f32 v89, v82, v83
  v_mul_f32 v84, v84, v92
  v_mul_f32 v84, v84, v10
  s_waitcnt lgkmcnt(5)
  v_mfma_f32_32x32x16_bf16 v[96:111], v[60:63], v[180:183], v[96:111]
  ds_read_b128 v[52:55], v1 offset:52224
  v_mul_f32 v85, v85, v93
  v_mul_f32 v85, v85, v10
  v_cvt_pk_bf16_f32 v90, v84, v85
  buffer_load_dwordx4 v1, s[4:7], s46 offen offset:2048 sc1 lds
  s_waitcnt lgkmcnt(5)
  v_mfma_f32_32x32x16_bf16 v[96:111], v[32:35], v[184:187], v[96:111]
  ds_read_b128 v[56:59], v1 offset:53248
  v_mul_f32 v86, v86, v94
  v_mul_f32 v86, v86, v10
  v_mul_f32_e64 v87, v87, v95
  s_waitcnt lgkmcnt(5)
  v_mfma_f32_32x32x16_bf16 v[96:111], v[36:39], v[188:191], v[96:111]
  ds_read_b128 v[60:63], v1 offset:54272
  v_mul_f32_e64 v87, v87, v10
  v_cvt_pk_bf16_f32 v91, v86, v87
  buffer_store_dwordx4 v[88:91], v1, s[4:7], s49 offen offset:1024 sc0 sc1
  buffer_load_dwordx4 v1, s[4:7], s46 offen offset:3072 sc1 lds
  s_waitcnt lgkmcnt(5)
  v_mfma_f32_32x32x16_bf16 v[96:111], v[40:43], v[192:195], v[96:111]
  ds_read_b128 v[32:35], v1 offset:55296
  s_waitcnt lgkmcnt(5)
  v_mfma_f32_32x32x16_bf16 v[96:111], v[44:47], v[196:199], v[96:111]
  ds_read_b128 v[36:39], v1 offset:56320
  s_add_u32 s46, s28, 163840
  s_add_u32 m0, s22, 0
  s_nop 0
  buffer_load_dwordx4 v1, s[4:7], s46 offen offset:0 sc1 lds
  s_waitcnt lgkmcnt(5)
  v_mfma_f32_32x32x16_bf16 v[96:111], v[48:51], v[200:203], v[96:111]
  ds_read_b128 v[40:43], v1 offset:57344
  s_waitcnt lgkmcnt(5)
  v_mfma_f32_32x32x16_bf16 v[96:111], v[52:55], v[204:207], v[96:111]
  ds_read_b128 v[44:47], v1 offset:58368
  buffer_load_dwordx4 v1, s[4:7], s46 offen offset:1024 sc1 lds
  s_waitcnt lgkmcnt(5)
  v_mfma_f32_32x32x16_bf16 v[96:111], v[56:59], v[208:211], v[96:111]
  ds_read_b128 v[48:51], v1 offset:59392
  s_waitcnt lgkmcnt(5)
  v_mfma_f32_32x32x16_bf16 v[96:111], v[60:63], v[212:215], v[96:111]
  ds_read_b128 v[52:55], v1 offset:60416
  buffer_load_dwordx4 v1, s[4:7], s46 offen offset:2048 sc1 lds
  s_waitcnt lgkmcnt(5)
  v_mfma_f32_32x32x16_bf16 v[96:111], v[32:35], v[216:219], v[96:111]
  ds_read_b128 v[56:59], v1 offset:61440
  s_waitcnt lgkmcnt(5)
  v_mfma_f32_32x32x16_bf16 v[96:111], v[36:39], v[220:223], v[96:111]
  ds_read_b128 v[60:63], v1 offset:62464
  buffer_load_dwordx4 v1, s[4:7], s46 offen offset:3072 sc1 lds
  s_waitcnt lgkmcnt(5)
  v_mfma_f32_32x32x16_bf16 v[96:111], v[40:43], v[224:227], v[96:111]
  ds_read_b128 v[32:35], v1 offset:63488
  s_waitcnt lgkmcnt(5)
  v_mfma_f32_32x32x16_bf16 v[96:111], v[44:47], v[228:231], v[96:111]
  ds_read_b128 v[36:39], v1 offset:64512
  s_add_u32 s46, s28, 167936
  s_add_u32 m0, s22, 4096
  s_nop 0
  buffer_load_dwordx4 v1, s[4:7], s46 offen offset:0 sc1 lds
  s_waitcnt lgkmcnt(5)
  v_mfma_f32_32x32x16_bf16 v[96:111], v[48:51], v[232:235], v[96:111]
  ds_read_b128 v[40:43], v3 offset:10240
  s_waitcnt lgkmcnt(5)
  v_mfma_f32_32x32x16_bf16 v[96:111], v[52:55], v[236:239], v[96:111]
  buffer_load_dwordx4 v1, s[4:7], s46 offen offset:1024 sc1 lds
  s_waitcnt lgkmcnt(4)
  v_mfma_f32_32x32x16_bf16 v[96:111], v[56:59], v[240:243], v[96:111]
  s_waitcnt vmcnt(16) lgkmcnt(0)
  s_barrier
  buffer_load_dwordx4 v1, s[4:7], s46 offen offset:2048 sc1 lds
  v_mfma_f32_32x32x16_bf16 v[96:111], v[60:63], v[244:247], v[96:111]
  ds_read_b128 v[44:47], v2 offset:32768
  ds_read_b128 v[48:51], v2 offset:33792
  ds_read_b128 v[52:55], v2 offset:34816
  v_mfma_f32_32x32x16_bf16 v[96:111], v[32:35], v[248:251], v[96:111]
  ds_read_b128 v[56:59], v2 offset:35840
  buffer_load_dwordx4 v1, s[4:7], s46 offen offset:3072 sc1 lds
  v_mfma_f32_32x32x16_bf16 v[96:111], v[36:39], v[252:255], v[96:111]
  ds_read_b128 v[60:63], v2 offset:36864
  v_mfma_f32_32x32x16_bf16 v[96:111], v[40:43], v[12:15], v[96:111]
  ds_read_b128 v[32:35], v2 offset:37888
  s_cbranch_vccz L31
  s_waitcnt lgkmcnt(5)
  v_mfma_f32_32x32x16_bf16 v[64:79], v[44:47], v[128:131], 0
  ds_read_b128 v[36:39], v2 offset:38912
  s_waitcnt lgkmcnt(5)
  v_mfma_f32_32x32x16_bf16 v[64:79], v[48:51], v[132:135], v[64:79]
  ds_read_b128 v[40:43], v2 offset:39936
  s_add_u32 s46, s28, 196608
  s_add_u32 m0, s22, 32768
  s_nop 0
  buffer_load_dwordx4 v1, s[4:7], s46 offen offset:0 sc1 lds
  s_waitcnt lgkmcnt(5)
  v_mfma_f32_32x32x16_bf16 v[64:79], v[52:55], v[136:139], v[64:79]
  ds_read_b128 v[44:47], v2 offset:40960
  v_mul_f32 v96, v96, v104
  v_mul_f32 v96, v96, v10
  v_mul_f32_e64 v97, v97, v105
  s_waitcnt lgkmcnt(5)
  v_mfma_f32_32x32x16_bf16 v[64:79], v[56:59], v[140:143], v[64:79]
  ds_read_b128 v[48:51], v2 offset:41984
  v_mul_f32_e64 v97, v97, v10
  v_cvt_pk_bf16_f32 v104, v96, v97
  v_mul_f32_e64 v98, v98, v106
  buffer_load_dwordx4 v1, s[4:7], s46 offen offset:1024 sc1 lds
  s_add_u32 s47, s30, 8192
  buffer_load_dwordx4 a[32:35], v1, s[4:7], s47 offen offset:0 sc1
  s_waitcnt lgkmcnt(5)
  v_mfma_f32_32x32x16_bf16 v[64:79], v[60:63], v[144:147], v[64:79]
  ds_read_b128 v[52:55], v2 offset:43008
  v_mul_f32 v98, v98, v10
  v_mul_f32 v99, v99, v107
  v_mul_f32_e64 v99, v99, v10
  s_waitcnt lgkmcnt(5)
  v_mfma_f32_32x32x16_bf16 v[64:79], v[32:35], v[148:151], v[64:79]
  ds_read_b128 v[56:59], v2 offset:44032
  v_cvt_pk_bf16_f32 v105, v98, v99
  v_mul_f32 v100, v100, v108
  v_mul_f32 v100, v100, v10
  buffer_load_dwordx4 v1, s[4:7], s46 offen offset:2048 sc1 lds
  s_waitcnt lgkmcnt(5)
  v_mfma_f32_32x32x16_bf16 v[64:79], v[36:39], v[152:155], v[64:79]
  ds_read_b128 v[60:63], v2 offset:45056
  v_mul_f32 v101, v101, v109
  v_mul_f32_e64 v101, v101, v10
  v_cvt_pk_bf16_f32 v106, v100, v101
  buffer_load_dwordx4 a[36:39], v1, s[4:7], s47 offen offset:1024 sc1
  s_waitcnt lgkmcnt(5)
  v_mfma_f32_32x32x16_bf16 v[64:79], v[40:43], v[156:159], v[64:79]
  ds_read_b128 v[32:35], v2 offset:46080
  v_mul_f32 v102, v102, v110
  v_mul_f32 v102, v102, v10
  v_mul_f32 v103, v103, v111
  buffer_load_dwordx4 v1, s[4:7], s46 offen offset:3072 sc1 lds
  s_waitcnt lgkmcnt(5)
  v_mfma_f32_32x32x16_bf16 v[64:79], v[44:47], v[160:163], v[64:79]
  ds_read_b128 v[36:39], v2 offset:47104
  v_mul_f32 v103, v103, v10
  v_cvt_pk_bf16_f32 v107, v102, v103
  buffer_store_dwordx4 v[104:107], v1, s[4:7], s49 offen offset:2048 sc0 sc1
  s_waitcnt lgkmcnt(5)
  v_mfma_f32_32x32x16_bf16 v[64:79], v[48:51], v[164:167], v[64:79]
  ds_read_b128 v[40:43], v2 offset:48128
  s_add_u32 s46, s28, 200704
  s_add_u32 m0, s22, 36864
  s_nop 0
  buffer_load_dwordx4 v1, s[4:7], s46 offen offset:0 sc1 lds
  buffer_load_dwordx4 a[40:43], v1, s[4:7], s47 offen offset:2048 sc1
  s_waitcnt lgkmcnt(5)
  v_mfma_f32_32x32x16_bf16 v[64:79], v[52:55], v[168:171], v[64:79]
  ds_read_b128 v[44:47], v2 offset:49152
  s_waitcnt lgkmcnt(5)
  v_mfma_f32_32x32x16_bf16 v[64:79], v[56:59], v[172:175], v[64:79]
  ds_read_b128 v[48:51], v2 offset:50176
  buffer_load_dwordx4 v1, s[4:7], s46 offen offset:1024 sc1 lds
  s_waitcnt lgkmcnt(5)
  v_mfma_f32_32x32x16_bf16 v[64:79], v[60:63], v[176:179], v[64:79]
  ds_read_b128 v[52:55], v2 offset:51200
  s_waitcnt lgkmcnt(5)
  v_mfma_f32_32x32x16_bf16 v[64:79], v[32:35], v[180:183], v[64:79]
  ds_read_b128 v[56:59], v2 offset:52224
  buffer_load_dwordx4 v1, s[4:7], s46 offen offset:2048 sc1 lds
  buffer_load_dwordx4 a[44:47], v1, s[4:7], s47 offen offset:3072 sc1
  s_waitcnt lgkmcnt(5)
  v_mfma_f32_32x32x16_bf16 v[64:79], v[36:39], v[184:187], v[64:79]
  ds_read_b128 v[60:63], v2 offset:53248
  s_waitcnt lgkmcnt(5)
  v_mfma_f32_32x32x16_bf16 v[64:79], v[40:43], v[188:191], v[64:79]
  ds_read_b128 v[32:35], v2 offset:54272
  buffer_load_dwordx4 v1, s[4:7], s46 offen offset:3072 sc1 lds
  s_waitcnt lgkmcnt(5)
  v_mfma_f32_32x32x16_bf16 v[64:79], v[44:47], v[192:195], v[64:79]
  ds_read_b128 v[36:39], v2 offset:55296
  s_add_u32 s47, s30, 12288
  buffer_load_dwordx4 a[48:51], v1, s[4:7], s47 offen offset:0 sc1
  s_waitcnt lgkmcnt(5)
  v_mfma_f32_32x32x16_bf16 v[64:79], v[48:51], v[196:199], v[64:79]
  ds_read_b128 v[40:43], v2 offset:56320
  s_waitcnt lgkmcnt(5)
  v_mfma_f32_32x32x16_bf16 v[64:79], v[52:55], v[200:203], v[64:79]
  ds_read_b128 v[44:47], v2 offset:57344
  s_waitcnt lgkmcnt(5)
  v_mfma_f32_32x32x16_bf16 v[64:79], v[56:59], v[204:207], v[64:79]
  ds_read_b128 v[48:51], v2 offset:58368
  buffer_load_dwordx4 a[52:55], v1, s[4:7], s47 offen offset:1024 sc1
  s_waitcnt lgkmcnt(5)
  v_mfma_f32_32x32x16_bf16 v[64:79], v[60:63], v[208:211], v[64:79]
  ds_read_b128 v[52:55], v2 offset:59392
  s_waitcnt lgkmcnt(5)
  v_mfma_f32_32x32x16_bf16 v[64:79], v[32:35], v[212:215], v[64:79]
  ds_read_b128 v[56:59], v2 offset:60416
  s_waitcnt vmcnt(15)
  s_barrier
  s_waitcnt lgkmcnt(5)
  v_mfma_f32_32x32x16_bf16 v[64:79], v[36:39], v[216:219], v[64:79]
  ds_read_b128 v[60:63], v2 offset:61440
  buffer_load_dwordx4 a[56:59], v1, s[4:7], s47 offen offset:2048 sc1
  s_waitcnt lgkmcnt(5)
  v_mfma_f32_32x32x16_bf16 v[64:79], v[40:43], v[220:223], v[64:79]
  ds_read_b128 v[32:35], v2 offset:62464
  s_waitcnt lgkmcnt(5)
  v_mfma_f32_32x32x16_bf16 v[64:79], v[44:47], v[224:227], v[64:79]
  ds_read_b128 v[36:39], v2 offset:63488
  s_waitcnt lgkmcnt(5)
  v_mfma_f32_32x32x16_bf16 v[64:79], v[48:51], v[228:231], v[64:79]
  ds_read_b128 v[40:43], v2 offset:64512
  buffer_load_dwordx4 a[60:63], v1, s[4:7], s47 offen offset:3072 sc1
  s_waitcnt lgkmcnt(5)
  v_mfma_f32_32x32x16_bf16 v[64:79], v[52:55], v[232:235], v[64:79]
  ds_read_b128 v[44:47], v3 offset:11264
  s_waitcnt lgkmcnt(5)
  v_mfma_f32_32x32x16_bf16 v[64:79], v[56:59], v[236:239], v[64:79]
  ds_read_b128 v[48:51], v2 offset:0
  s_waitcnt lgkmcnt(5)
  v_mfma_f32_32x32x16_bf16 v[64:79], v[60:63], v[240:243], v[64:79]
  ds_read_b128 v[52:55], v2 offset:1024
  s_add_u32 s47, s30, 16384
  buffer_load_dwordx4 a[64:67], v1, s[4:7], s47 offen offset:0 sc1
  s_waitcnt lgkmcnt(5)
  v_mfma_f32_32x32x16_bf16 v[64:79], v[32:35], v[244:247], v[64:79]
  ds_read_b128 v[56:59], v2 offset:2048
  s_waitcnt lgkmcnt(5)
  v_mfma_f32_32x32x16_bf16 v[64:79], v[36:39], v[248:251], v[64:79]
  ds_read_b128 v[60:63], v2 offset:3072
  s_waitcnt lgkmcnt(5)
  v_mfma_f32_32x32x16_bf16 v[64:79], v[40:43], v[252:255], v[64:79]
  ds_read_b128 v[32:35], v2 offset:4096
  s_waitcnt lgkmcnt(5)
  v_mfma_f32_32x32x16_bf16 v[64:79], v[44:47], v[12:15], v[64:79]
  ds_read_b128 v[36:39], v2 offset:5120
  buffer_load_dwordx4 a[68:71], v1, s[4:7], s47 offen offset:1024 sc1
  s_waitcnt lgkmcnt(5)
  v_mfma_f32_32x32x16_bf16 v[80:95], v[48:51], v[128:131], 0
  ds_read_b128 v[40:43], v2 offset:6144
  s_waitcnt lgkmcnt(5)
  v_mfma_f32_32x32x16_bf16 v[80:95], v[52:55], v[132:135], v[80:95]
  ds_read_b128 v[44:47], v2 offset:7168
  buffer_load_dwordx4 a[72:75], v1, s[4:7], s47 offen offset:2048 sc1
  s_waitcnt lgkmcnt(5)
  v_mfma_f32_32x32x16_bf16 v[80:95], v[56:59], v[136:139], v[80:95]
  ds_read_b128 v[48:51], v2 offset:8192
  v_mul_f32 v64, v64, v72
  v_mul_f32 v64, v64, v10
  v_mul_f32 v65, v65, v73
  s_waitcnt lgkmcnt(5)
  v_mfma_f32_32x32x16_bf16 v[80:95], v[60:63], v[140:143], v[80:95]
  ds_read_b128 v[52:55], v2 offset:9216
  v_mul_f32_e64 v65, v65, v10
  v_cvt_pk_bf16_f32 v72, v64, v65
  v_mul_f32_e64 v66, v66, v74
  buffer_load_dwordx4 a[76:79], v1, s[4:7], s47 offen offset:3072 sc1
  s_waitcnt lgkmcnt(5)
  v_mfma_f32_32x32x16_bf16 v[80:95], v[32:35], v[144:147], v[80:95]
  ds_read_b128 v[56:59], v2 offset:10240
  v_mul_f32 v66, v66, v10
  v_mul_f32 v67, v67, v75
  v_mul_f32_e64 v67, v67, v10
  s_waitcnt lgkmcnt(5)
  v_mfma_f32_32x32x16_bf16 v[80:95], v[36:39], v[148:151], v[80:95]
  ds_read_b128 v[60:63], v2 offset:11264
  v_cvt_pk_bf16_f32 v73, v66, v67
  v_mul_f32 v68, v68, v76
  v_mul_f32 v68, v68, v10
  s_add_u32 s47, s30, 20480
  buffer_load_dwordx4 a[80:83], v1, s[4:7], s47 offen offset:0 sc1
  s_waitcnt lgkmcnt(5)
  v_mfma_f32_32x32x16_bf16 v[80:95], v[40:43], v[152:155], v[80:95]
  ds_read_b128 v[32:35], v2 offset:12288
  v_mul_f32 v69, v69, v77
  v_mul_f32_e64 v69, v69, v10
  v_cvt_pk_bf16_f32 v74, v68, v69
  s_waitcnt lgkmcnt(5)
  v_mfma_f32_32x32x16_bf16 v[80:95], v[44:47], v[156:159], v[80:95]
  ds_read_b128 v[36:39], v2 offset:13312
  v_mul_f32 v70, v70, v78
  v_mul_f32 v70, v70, v10
  v_mul_f32 v71, v71, v79
  buffer_load_dwordx4 a[84:87], v1, s[4:7], s47 offen offset:1024 sc1
  s_waitcnt lgkmcnt(5)
  v_mfma_f32_32x32x16_bf16 v[80:95], v[48:51], v[160:163], v[80:95]
  ds_read_b128 v[40:43], v2 offset:14336
  v_mul_f32 v71, v71, v10
  v_cvt_pk_bf16_f32 v75, v70, v71
  buffer_store_dwordx4 v[72:75], v1, s[4:7], s49 offen offset:3072 sc0 sc1
  buffer_load_dwordx4 a[88:91], v1, s[4:7], s47 offen offset:2048 sc1
  s_waitcnt lgkmcnt(5)
  v_mfma_f32_32x32x16_bf16 v[80:95], v[52:55], v[164:167], v[80:95]
  ds_read_b128 v[44:47], v2 offset:15360
  s_waitcnt lgkmcnt(5)
  v_mfma_f32_32x32x16_bf16 v[80:95], v[56:59], v[168:171], v[80:95]
  ds_read_b128 v[48:51], v2 offset:16384
  buffer_load_dwordx4 a[92:95], v1, s[4:7], s47 offen offset:3072 sc1
  s_waitcnt lgkmcnt(5)
  v_mfma_f32_32x32x16_bf16 v[80:95], v[60:63], v[172:175], v[80:95]
  ds_read_b128 v[52:55], v2 offset:17408
  s_waitcnt lgkmcnt(5)
  v_mfma_f32_32x32x16_bf16 v[80:95], v[32:35], v[176:179], v[80:95]
  ds_read_b128 v[56:59], v2 offset:18432
  s_add_u32 s47, s30, 24576
  buffer_load_dwordx4 a[96:99], v1, s[4:7], s47 offen offset:0 sc1
  s_waitcnt lgkmcnt(5)
  v_mfma_f32_32x32x16_bf16 v[80:95], v[36:39], v[180:183], v[80:95]
  ds_read_b128 v[60:63], v2 offset:19456
  s_waitcnt lgkmcnt(5)
  v_mfma_f32_32x32x16_bf16 v[80:95], v[40:43], v[184:187], v[80:95]
  ds_read_b128 v[32:35], v2 offset:20480
  buffer_load_dwordx4 a[100:103], v1, s[4:7], s47 offen offset:1024 sc1
  s_waitcnt lgkmcnt(5)
  v_mfma_f32_32x32x16_bf16 v[80:95], v[44:47], v[188:191], v[80:95]
  ds_read_b128 v[36:39], v2 offset:21504
  buffer_load_dwordx4 a[104:107], v1, s[4:7], s47 offen offset:2048 sc1
  s_waitcnt lgkmcnt(5)
  v_mfma_f32_32x32x16_bf16 v[80:95], v[48:51], v[192:195], v[80:95]
  ds_read_b128 v[40:43], v2 offset:22528
  s_waitcnt lgkmcnt(5)
  v_mfma_f32_32x32x16_bf16 v[80:95], v[52:55], v[196:199], v[80:95]
  ds_read_b128 v[44:47], v2 offset:23552
  buffer_load_dwordx4 a[108:111], v1, s[4:7], s47 offen offset:3072 sc1
  s_waitcnt lgkmcnt(5)
  v_mfma_f32_32x32x16_bf16 v[80:95], v[56:59], v[200:203], v[80:95]
  ds_read_b128 v[48:51], v2 offset:24576
  s_waitcnt lgkmcnt(5)
  v_mfma_f32_32x32x16_bf16 v[80:95], v[60:63], v[204:207], v[80:95]
  ds_read_b128 v[52:55], v2 offset:25600
  s_add_u32 s47, s30, 28672
  buffer_load_dwordx4 a[112:115], v1, s[4:7], s47 offen offset:0 sc1
  s_waitcnt lgkmcnt(5)
  v_mfma_f32_32x32x16_bf16 v[80:95], v[32:35], v[208:211], v[80:95]
  ds_read_b128 v[56:59], v2 offset:26624
  s_waitcnt lgkmcnt(5)
  v_mfma_f32_32x32x16_bf16 v[80:95], v[36:39], v[212:215], v[80:95]
  ds_read_b128 v[60:63], v2 offset:27648
  buffer_load_dwordx4 a[116:119], v1, s[4:7], s47 offen offset:1024 sc1
  s_waitcnt vmcnt(19)
  s_barrier
  buffer_load_dwordx4 a[120:123], v1, s[4:7], s47 offen offset:2048 sc1
  s_waitcnt lgkmcnt(5)
  v_mfma_f32_32x32x16_bf16 v[80:95], v[40:43], v[216:219], v[80:95]
  ds_read_b128 v[32:35], v2 offset:28672
  s_waitcnt lgkmcnt(5)
  v_mfma_f32_32x32x16_bf16 v[80:95], v[44:47], v[220:223], v[80:95]
  ds_read_b128 v[36:39], v2 offset:29696
  buffer_load_dwordx4 a[124:127], v1, s[4:7], s47 offen offset:3072 sc1
  s_waitcnt lgkmcnt(5)
  v_mfma_f32_32x32x16_bf16 v[80:95], v[48:51], v[224:227], v[80:95]
  ds_read_b128 v[40:43], v2 offset:30720
  s_waitcnt lgkmcnt(5)
  v_mfma_f32_32x32x16_bf16 v[80:95], v[52:55], v[228:231], v[80:95]
  ds_read_b128 v[44:47], v2 offset:31744
  s_add_u32 s47, s30, 32768
  buffer_load_dwordx4 a[128:131], v1, s[4:7], s47 offen offset:0 sc1
  s_waitcnt lgkmcnt(5)
  v_mfma_f32_32x32x16_bf16 v[80:95], v[56:59], v[232:235], v[80:95]
  ds_read_b128 v[48:51], v3 offset:12288
  s_waitcnt lgkmcnt(5)
  v_mfma_f32_32x32x16_bf16 v[80:95], v[60:63], v[236:239], v[80:95]
  ds_read_b128 v[52:55], v1 offset:0
  buffer_load_dwordx4 a[132:135], v1, s[4:7], s47 offen offset:1024 sc1
  s_waitcnt lgkmcnt(5)
  v_mfma_f32_32x32x16_bf16 v[80:95], v[32:35], v[240:243], v[80:95]
  ds_read_b128 v[56:59], v1 offset:1024
  buffer_load_dwordx4 a[136:139], v1, s[4:7], s47 offen offset:2048 sc1
  s_waitcnt lgkmcnt(5)
  v_mfma_f32_32x32x16_bf16 v[80:95], v[36:39], v[244:247], v[80:95]
  ds_read_b128 v[60:63], v1 offset:2048
  s_waitcnt lgkmcnt(5)
  v_mfma_f32_32x32x16_bf16 v[80:95], v[40:43], v[248:251], v[80:95]
  ds_read_b128 v[32:35], v1 offset:3072
  buffer_load_dwordx4 a[140:143], v1, s[4:7], s47 offen offset:3072 sc1
  s_waitcnt lgkmcnt(5)
  v_mfma_f32_32x32x16_bf16 v[80:95], v[44:47], v[252:255], v[80:95]
  ds_read_b128 v[36:39], v1 offset:4096
  s_waitcnt lgkmcnt(5)
  v_mfma_f32_32x32x16_bf16 v[80:95], v[48:51], v[12:15], v[80:95]
  ds_read_b128 v[40:43], v1 offset:5120
  s_add_u32 s47, s30, 36864
  buffer_load_dwordx4 a[144:147], v1, s[4:7], s47 offen offset:0 sc1
  s_waitcnt lgkmcnt(5)
  v_mfma_f32_32x32x16_bf16 v[96:111], v[52:55], v[128:131], 0
  ds_read_b128 v[44:47], v1 offset:6144
  s_waitcnt lgkmcnt(5)
  v_mfma_f32_32x32x16_bf16 v[96:111], v[56:59], v[132:135], v[96:111]
  ds_read_b128 v[48:51], v1 offset:7168
  buffer_load_dwordx4 a[148:151], v1, s[4:7], s47 offen offset:1024 sc1
  s_waitcnt vmcnt(16)
  s_mov_b32 s52, 1
  s_atomic_add s52, s[12:13], s54
  v_mul_f32 v80, v80, v88
  v_mul_f32 v80, v80, v10
  v_mul_f32 v81, v81, v89
  s_waitcnt lgkmcnt(5)
  v_mfma_f32_32x32x16_bf16 v[96:111], v[60:63], v[136:139], v[96:111]
  ds_read_b128 v[52:55], v1 offset:8192
  v_mul_f32_e64 v81, v81, v10
  v_cvt_pk_bf16_f32 v88, v80, v81
  v_mul_f32_e64 v82, v82, v90
  buffer_load_dwordx4 a[152:155], v1, s[4:7], s47 offen offset:2048 sc1
  s_waitcnt lgkmcnt(5)
  v_mfma_f32_32x32x16_bf16 v[96:111], v[32:35], v[140:143], v[96:111]
  ds_read_b128 v[56:59], v1 offset:9216
  v_mul_f32 v82, v82, v10
  v_mul_f32 v83, v83, v91
  v_mul_f32_e64 v83, v83, v10
  s_waitcnt lgkmcnt(5)
  v_mfma_f32_32x32x16_bf16 v[96:111], v[36:39], v[144:147], v[96:111]
  ds_read_b128 v[60:63], v1 offset:10240
  v_cvt_pk_bf16_f32 v89, v82, v83
  v_mul_f32 v84, v84, v92
  v_mul_f32 v84, v84, v10
  buffer_load_dwordx4 a[156:159], v1, s[4:7], s47 offen offset:3072 sc1
  s_waitcnt lgkmcnt(5)
  v_mfma_f32_32x32x16_bf16 v[96:111], v[40:43], v[148:151], v[96:111]
  ds_read_b128 v[32:35], v1 offset:11264
  v_mul_f32 v85, v85, v93
  v_mul_f32_e64 v85, v85, v10
  v_cvt_pk_bf16_f32 v90, v84, v85
  s_waitcnt lgkmcnt(5)
  v_mfma_f32_32x32x16_bf16 v[96:111], v[44:47], v[152:155], v[96:111]
  ds_read_b128 v[36:39], v1 offset:12288
  v_mul_f32 v86, v86, v94
  v_mul_f32 v86, v86, v10
  v_mul_f32 v87, v87, v95
  s_add_u32 s47, s30, 40960
  buffer_load_dwordx4 a[160:163], v1, s[4:7], s47 offen offset:0 sc1
  s_waitcnt lgkmcnt(5)
  v_mfma_f32_32x32x16_bf16 v[96:111], v[48:51], v[156:159], v[96:111]
  ds_read_b128 v[40:43], v1 offset:13312
  v_mul_f32 v87, v87, v10
  v_cvt_pk_bf16_f32 v91, v86, v87
  s_add_u32 s53, s49, 4096
  buffer_store_dwordx4 v[88:91], v1, s[4:7], s53 offen offset:0 sc0 sc1
  buffer_load_dwordx4 a[164:167], v1, s[4:7], s47 offen offset:1024 sc1
  s_waitcnt lgkmcnt(5)
  v_mfma_f32_32x32x16_bf16 v[96:111], v[52:55], v[160:163], v[96:111]
  ds_read_b128 v[44:47], v1 offset:14336
  s_waitcnt lgkmcnt(5)
  v_mfma_f32_32x32x16_bf16 v[96:111], v[56:59], v[164:167], v[96:111]
  ds_read_b128 v[48:51], v1 offset:15360
  buffer_load_dwordx4 a[168:171], v1, s[4:7], s47 offen offset:2048 sc1
  s_waitcnt lgkmcnt(5)
  v_mfma_f32_32x32x16_bf16 v[96:111], v[60:63], v[168:171], v[96:111]
  ds_read_b128 v[52:55], v1 offset:16384
  s_waitcnt lgkmcnt(5)
  v_mfma_f32_32x32x16_bf16 v[96:111], v[32:35], v[172:175], v[96:111]
  ds_read_b128 v[56:59], v1 offset:17408
  buffer_load_dwordx4 a[172:175], v1, s[4:7], s47 offen offset:3072 sc1
  s_waitcnt lgkmcnt(5)
  v_mfma_f32_32x32x16_bf16 v[96:111], v[36:39], v[176:179], v[96:111]
  ds_read_b128 v[60:63], v1 offset:18432
  s_waitcnt lgkmcnt(5)
  v_mfma_f32_32x32x16_bf16 v[96:111], v[40:43], v[180:183], v[96:111]
  ds_read_b128 v[32:35], v1 offset:19456
  s_add_u32 s47, s30, 45056
  buffer_load_dwordx4 a[176:179], v1, s[4:7], s47 offen offset:0 sc1
  s_waitcnt lgkmcnt(5)
  v_mfma_f32_32x32x16_bf16 v[96:111], v[44:47], v[184:187], v[96:111]
  ds_read_b128 v[36:39], v1 offset:20480
  buffer_load_dwordx4 a[180:183], v1, s[4:7], s47 offen offset:1024 sc1
  s_waitcnt lgkmcnt(5)
  v_mfma_f32_32x32x16_bf16 v[96:111], v[48:51], v[188:191], v[96:111]
  ds_read_b128 v[40:43], v1 offset:21504
  s_waitcnt lgkmcnt(5)
  v_mfma_f32_32x32x16_bf16 v[96:111], v[52:55], v[192:195], v[96:111]
  ds_read_b128 v[44:47], v1 offset:22528
  buffer_load_dwordx4 a[184:187], v1, s[4:7], s47 offen offset:2048 sc1
  s_waitcnt lgkmcnt(5)
  v_mfma_f32_32x32x16_bf16 v[96:111], v[56:59], v[196:199], v[96:111]
  ds_read_b128 v[48:51], v1 offset:23552
  s_waitcnt lgkmcnt(5)
  v_mfma_f32_32x32x16_bf16 v[96:111], v[60:63], v[200:203], v[96:111]
  ds_read_b128 v[52:55], v1 offset:24576
  buffer_load_dwordx4 a[188:191], v1, s[4:7], s47 offen offset:3072 sc1
  s_waitcnt lgkmcnt(5)
  v_mfma_f32_32x32x16_bf16 v[96:111], v[32:35], v[204:207], v[96:111]
  ds_read_b128 v[56:59], v1 offset:25600
  s_waitcnt lgkmcnt(5)
  v_mfma_f32_32x32x16_bf16 v[96:111], v[36:39], v[208:211], v[96:111]
  ds_read_b128 v[60:63], v1 offset:26624
  s_add_u32 s47, s30, 49152
  buffer_load_dwordx4 a[192:195], v1, s[4:7], s47 offen offset:0 sc1
  s_waitcnt lgkmcnt(5)
  v_mfma_f32_32x32x16_bf16 v[96:111], v[40:43], v[212:215], v[96:111]
  ds_read_b128 v[32:35], v1 offset:27648
  buffer_load_dwordx4 a[196:199], v1, s[4:7], s47 offen offset:1024 sc1
  s_waitcnt lgkmcnt(5)
  v_mfma_f32_32x32x16_bf16 v[96:111], v[44:47], v[216:219], v[96:111]
  ds_read_b128 v[36:39], v1 offset:28672
  s_waitcnt lgkmcnt(5)
  v_mfma_f32_32x32x16_bf16 v[96:111], v[48:51], v[220:223], v[96:111]
  ds_read_b128 v[40:43], v1 offset:29696
  buffer_load_dwordx4 a[200:203], v1, s[4:7], s47 offen offset:2048 sc1
  s_waitcnt lgkmcnt(5)
  v_mfma_f32_32x32x16_bf16 v[96:111], v[52:55], v[224:227], v[96:111]
  ds_read_b128 v[44:47], v1 offset:30720
  s_waitcnt lgkmcnt(5)
  v_mfma_f32_32x32x16_bf16 v[96:111], v[56:59], v[228:231], v[96:111]
  ds_read_b128 v[48:51], v1 offset:31744
  buffer_load_dwordx4 a[204:207], v1, s[4:7], s47 offen offset:3072 sc1
  s_waitcnt lgkmcnt(5)
  v_mfma_f32_32x32x16_bf16 v[96:111], v[60:63], v[232:235], v[96:111]
  ds_read_b128 v[52:55], v3 offset:13312
  s_waitcnt lgkmcnt(5)
  v_mfma_f32_32x32x16_bf16 v[96:111], v[32:35], v[236:239], v[96:111]
  ds_read_b128 v[56:59], v1 offset:32768
  s_add_u32 s47, s30, 53248
  buffer_load_dwordx4 a[208:211], v1, s[4:7], s47 offen offset:0 sc1
  s_waitcnt lgkmcnt(5)
  v_mfma_f32_32x32x16_bf16 v[96:111], v[36:39], v[240:243], v[96:111]
  ds_read_b128 v[60:63], v1 offset:33792
  buffer_load_dwordx4 a[212:215], v1, s[4:7], s47 offen offset:1024 sc1
  s_waitcnt lgkmcnt(5)
  v_mfma_f32_32x32x16_bf16 v[96:111], v[40:43], v[244:247], v[96:111]
  ds_read_b128 v[32:35], v1 offset:34816
  s_waitcnt lgkmcnt(5)
  v_mfma_f32_32x32x16_bf16 v[96:111], v[44:47], v[248:251], v[96:111]
  ds_read_b128 v[36:39], v1 offset:35840
  buffer_load_dwordx4 a[216:219], v1, s[4:7], s47 offen offset:2048 sc1
  s_waitcnt lgkmcnt(5)
  v_mfma_f32_32x32x16_bf16 v[96:111], v[48:51], v[252:255], v[96:111]
  ds_read_b128 v[40:43], v1 offset:36864
  s_waitcnt lgkmcnt(5)
  v_mfma_f32_32x32x16_bf16 v[96:111], v[52:55], v[12:15], v[96:111]
  ds_read_b128 v[44:47], v1 offset:37888
  buffer_load_dwordx4 a[220:223], v1, s[4:7], s47 offen offset:3072 sc1
  s_branch L32
L31:
  s_waitcnt lgkmcnt(5)
  v_mfma_f32_32x32x16_bf16 v[64:79], v[44:47], v[128:131], 0
  ds_read_b128 v[36:39], v2 offset:38912
  s_waitcnt lgkmcnt(5)
  v_mfma_f32_32x32x16_bf16 v[64:79], v[48:51], v[132:135], v[64:79]
  ds_read_b128 v[40:43], v2 offset:39936
  s_add_u32 s46, s28, 196608
  s_add_u32 m0, s22, 32768
  s_nop 0
  buffer_load_dwordx4 v1, s[4:7], s46 offen offset:0 sc1 lds
  s_waitcnt lgkmcnt(5)
  v_mfma_f32_32x32x16_bf16 v[64:79], v[52:55], v[136:139], v[64:79]
  ds_read_b128 v[44:47], v2 offset:40960
  v_mul_f32 v96, v96, v104
  v_mul_f32 v96, v96, v10
  v_mul_f32 v97, v97, v105
  s_waitcnt lgkmcnt(5)
  v_mfma_f32_32x32x16_bf16 v[64:79], v[56:59], v[140:143], v[64:79]
  ds_read_b128 v[48:51], v2 offset:41984
  v_mul_f32_e64 v97, v97, v10
  v_cvt_pk_bf16_f32 v104, v96, v97
  v_mul_f32_e64 v98, v98, v106
  buffer_load_dwordx4 v1, s[4:7], s46 offen offset:1024 sc1 lds
  s_waitcnt lgkmcnt(5)
  v_mfma_f32_32x32x16_bf16 v[64:79], v[60:63], v[144:147], v[64:79]
  ds_read_b128 v[52:55], v2 offset:43008
  v_mul_f32 v98, v98, v10
  v_mul_f32 v99, v99, v107
  v_mul_f32_e64 v99, v99, v10
  s_waitcnt lgkmcnt(5)
  v_mfma_f32_32x32x16_bf16 v[64:79], v[32:35], v[148:151], v[64:79]
  ds_read_b128 v[56:59], v2 offset:44032
  v_cvt_pk_bf16_f32 v105, v98, v99
  v_mul_f32 v100, v100, v108
  v_mul_f32 v100, v100, v10
  buffer_load_dwordx4 v1, s[4:7], s46 offen offset:2048 sc1 lds
  s_waitcnt lgkmcnt(5)
  v_mfma_f32_32x32x16_bf16 v[64:79], v[36:39], v[152:155], v[64:79]
  ds_read_b128 v[60:63], v2 offset:45056
  v_mul_f32 v101, v101, v109
  v_mul_f32_e64 v101, v101, v10
  v_cvt_pk_bf16_f32 v106, v100, v101
  s_waitcnt lgkmcnt(5)
  v_mfma_f32_32x32x16_bf16 v[64:79], v[40:43], v[156:159], v[64:79]
  ds_read_b128 v[32:35], v2 offset:46080
  v_mul_f32 v102, v102, v110
  v_mul_f32 v102, v102, v10
  v_mul_f32 v103, v103, v111
  buffer_load_dwordx4 v1, s[4:7], s46 offen offset:3072 sc1 lds
  s_waitcnt lgkmcnt(5)
  v_mfma_f32_32x32x16_bf16 v[64:79], v[44:47], v[160:163], v[64:79]
  ds_read_b128 v[36:39], v2 offset:47104
  v_mul_f32 v103, v103, v10
  v_cvt_pk_bf16_f32 v107, v102, v103
  buffer_store_dwordx4 v[104:107], v1, s[4:7], s49 offen offset:2048 sc0 sc1
  s_waitcnt lgkmcnt(5)
  v_mfma_f32_32x32x16_bf16 v[64:79], v[48:51], v[164:167], v[64:79]
  ds_read_b128 v[40:43], v2 offset:48128
  s_add_u32 s46, s28, 200704
  s_add_u32 m0, s22, 36864
  s_nop 0
  buffer_load_dwordx4 v1, s[4:7], s46 offen offset:0 sc1 lds
  s_waitcnt lgkmcnt(5)
  v_mfma_f32_32x32x16_bf16 v[64:79], v[52:55], v[168:171], v[64:79]
  ds_read_b128 v[44:47], v2 offset:49152
  s_waitcnt lgkmcnt(5)
  v_mfma_f32_32x32x16_bf16 v[64:79], v[56:59], v[172:175], v[64:79]
  ds_read_b128 v[48:51], v2 offset:50176
  buffer_load_dwordx4 v1, s[4:7], s46 offen offset:1024 sc1 lds
  s_waitcnt lgkmcnt(5)
  v_mfma_f32_32x32x16_bf16 v[64:79], v[60:63], v[176:179], v[64:79]
  ds_read_b128 v[52:55], v2 offset:51200
  s_waitcnt lgkmcnt(5)
  v_mfma_f32_32x32x16_bf16 v[64:79], v[32:35], v[180:183], v[64:79]
  ds_read_b128 v[56:59], v2 offset:52224
  buffer_load_dwordx4 v1, s[4:7], s46 offen offset:2048 sc1 lds
  s_waitcnt lgkmcnt(5)
  v_mfma_f32_32x32x16_bf16 v[64:79], v[36:39], v[184:187], v[64:79]
  ds_read_b128 v[60:63], v2 offset:53248
  s_waitcnt lgkmcnt(5)
  v_mfma_f32_32x32x16_bf16 v[64:79], v[40:43], v[188:191], v[64:79]
  ds_read_b128 v[32:35], v2 offset:54272
  buffer_load_dwordx4 v1, s[4:7], s46 offen offset:3072 sc1 lds
  s_waitcnt lgkmcnt(5)
  v_mfma_f32_32x32x16_bf16 v[64:79], v[44:47], v[192:195], v[64:79]
  ds_read_b128 v[36:39], v2 offset:55296
  s_waitcnt lgkmcnt(5)
  v_mfma_f32_32x32x16_bf16 v[64:79], v[48:51], v[196:199], v[64:79]
  ds_read_b128 v[40:43], v2 offset:56320
  s_waitcnt lgkmcnt(5)
  v_mfma_f32_32x32x16_bf16 v[64:79], v[52:55], v[200:203], v[64:79]
  ds_read_b128 v[44:47], v2 offset:57344
  s_waitcnt lgkmcnt(5)
  v_mfma_f32_32x32x16_bf16 v[64:79], v[56:59], v[204:207], v[64:79]
  ds_read_b128 v[48:51], v2 offset:58368
  s_waitcnt lgkmcnt(5)
  v_mfma_f32_32x32x16_bf16 v[64:79], v[60:63], v[208:211], v[64:79]
  ds_read_b128 v[52:55], v2 offset:59392
  s_waitcnt lgkmcnt(5)
  v_mfma_f32_32x32x16_bf16 v[64:79], v[32:35], v[212:215], v[64:79]
  ds_read_b128 v[56:59], v2 offset:60416
  s_waitcnt vmcnt(9)
  s_barrier
  s_waitcnt lgkmcnt(5)
  v_mfma_f32_32x32x16_bf16 v[64:79], v[36:39], v[216:219], v[64:79]
  ds_read_b128 v[60:63], v2 offset:61440
  s_waitcnt lgkmcnt(5)
  v_mfma_f32_32x32x16_bf16 v[64:79], v[40:43], v[220:223], v[64:79]
  ds_read_b128 v[32:35], v2 offset:62464
  s_waitcnt lgkmcnt(5)
  v_mfma_f32_32x32x16_bf16 v[64:79], v[44:47], v[224:227], v[64:79]
  ds_read_b128 v[36:39], v2 offset:63488
  s_waitcnt lgkmcnt(5)
  v_mfma_f32_32x32x16_bf16 v[64:79], v[48:51], v[228:231], v[64:79]
  ds_read_b128 v[40:43], v2 offset:64512
  s_waitcnt lgkmcnt(5)
  v_mfma_f32_32x32x16_bf16 v[64:79], v[52:55], v[232:235], v[64:79]
  ds_read_b128 v[44:47], v3 offset:11264
  s_waitcnt lgkmcnt(5)
  v_mfma_f32_32x32x16_bf16 v[64:79], v[56:59], v[236:239], v[64:79]
  ds_read_b128 v[48:51], v2 offset:0
  s_waitcnt lgkmcnt(5)
  v_mfma_f32_32x32x16_bf16 v[64:79], v[60:63], v[240:243], v[64:79]
  ds_read_b128 v[52:55], v2 offset:1024
  s_waitcnt lgkmcnt(5)
  v_mfma_f32_32x32x16_bf16 v[64:79], v[32:35], v[244:247], v[64:79]
  ds_read_b128 v[56:59], v2 offset:2048
  s_waitcnt lgkmcnt(5)
  v_mfma_f32_32x32x16_bf16 v[64:79], v[36:39], v[248:251], v[64:79]
  ds_read_b128 v[60:63], v2 offset:3072
  s_waitcnt lgkmcnt(5)
  v_mfma_f32_32x32x16_bf16 v[64:79], v[40:43], v[252:255], v[64:79]
  ds_read_b128 v[32:35], v2 offset:4096
  s_waitcnt lgkmcnt(5)
  v_mfma_f32_32x32x16_bf16 v[64:79], v[44:47], v[12:15], v[64:79]
  ds_read_b128 v[36:39], v2 offset:5120
  s_waitcnt lgkmcnt(5)
  v_mfma_f32_32x32x16_bf16 v[80:95], v[48:51], v[128:131], 0
  ds_read_b128 v[40:43], v2 offset:6144
  s_waitcnt lgkmcnt(5)
  v_mfma_f32_32x32x16_bf16 v[80:95], v[52:55], v[132:135], v[80:95]
  ds_read_b128 v[44:47], v2 offset:7168
  s_waitcnt lgkmcnt(5)
  v_mfma_f32_32x32x16_bf16 v[80:95], v[56:59], v[136:139], v[80:95]
  ds_read_b128 v[48:51], v2 offset:8192
  s_nop 1
  v_mul_f32 v64, v64, v72
  v_mul_f32 v64, v64, v10
  v_mul_f32_e64 v65, v65, v73
  s_waitcnt lgkmcnt(5)
  v_mfma_f32_32x32x16_bf16 v[80:95], v[60:63], v[140:143], v[80:95]
  ds_read_b128 v[52:55], v2 offset:9216
  v_mul_f32_e64 v65, v65, v10
  v_cvt_pk_bf16_f32 v72, v64, v65
  v_mul_f32 v66, v66, v74
  s_waitcnt lgkmcnt(5)
  v_mfma_f32_32x32x16_bf16 v[80:95], v[32:35], v[144:147], v[80:95]
  ds_read_b128 v[56:59], v2 offset:10240
  v_mul_f32 v66, v66, v10
  v_mul_f32 v67, v67, v75
  v_mul_f32 v67, v67, v10
  s_waitcnt lgkmcnt(5)
  v_mfma_f32_32x32x16_bf16 v[80:95], v[36:39], v[148:151], v[80:95]
  ds_read_b128 v[60:63], v2 offset:11264
  v_cvt_pk_bf16_f32 v73, v66, v67
  v_mul_f32 v68, v68, v76
  v_mul_f32_e64 v68, v68, v10
  s_waitcnt lgkmcnt(5)
  v_mfma_f32_32x32x16_bf16 v[80:95], v[40:43], v[152:155], v[80:95]
  ds_read_b128 v[32:35], v2 offset:12288
  v_mul_f32 v69, v69, v77
  v_mul_f32 v69, v69, v10
  v_cvt_pk_bf16_f32 v74, v68, v69
  s_waitcnt lgkmcnt(5)
  v_mfma_f32_32x32x16_bf16 v[80:95], v[44:47], v[156:159], v[80:95]
  ds_read_b128 v[36:39], v2 offset:13312
  v_mul_f32 v70, v70, v78
  v_mul_f32 v70, v70, v10
  v_mul_f32_e64 v71, v71, v79
  s_waitcnt lgkmcnt(5)
  v_mfma_f32_32x32x16_bf16 v[80:95], v[48:51], v[160:163], v[80:95]
  ds_read_b128 v[40:43], v2 offset:14336
  v_mul_f32_e64 v71, v71, v10
  v_cvt_pk_bf16_f32 v75, v70, v71
  buffer_store_dwordx4 v[72:75], v1, s[4:7], s49 offen offset:3072 sc0 sc1
  s_waitcnt lgkmcnt(5)
  v_mfma_f32_32x32x16_bf16 v[80:95], v[52:55], v[164:167], v[80:95]
  ds_read_b128 v[44:47], v2 offset:15360
  s_waitcnt lgkmcnt(5)
  v_mfma_f32_32x32x16_bf16 v[80:95], v[56:59], v[168:171], v[80:95]
  ds_read_b128 v[48:51], v2 offset:16384
  s_waitcnt lgkmcnt(5)
  v_mfma_f32_32x32x16_bf16 v[80:95], v[60:63], v[172:175], v[80:95]
  ds_read_b128 v[52:55], v2 offset:17408
  s_waitcnt lgkmcnt(5)
  v_mfma_f32_32x32x16_bf16 v[80:95], v[32:35], v[176:179], v[80:95]
  ds_read_b128 v[56:59], v2 offset:18432
  s_waitcnt lgkmcnt(5)
  v_mfma_f32_32x32x16_bf16 v[80:95], v[36:39], v[180:183], v[80:95]
  ds_read_b128 v[60:63], v2 offset:19456
  s_waitcnt lgkmcnt(5)
  v_mfma_f32_32x32x16_bf16 v[80:95], v[40:43], v[184:187], v[80:95]
  ds_read_b128 v[32:35], v2 offset:20480
  s_waitcnt lgkmcnt(5)
  v_mfma_f32_32x32x16_bf16 v[80:95], v[44:47], v[188:191], v[80:95]
  ds_read_b128 v[36:39], v2 offset:21504
  s_waitcnt lgkmcnt(5)
  v_mfma_f32_32x32x16_bf16 v[80:95], v[48:51], v[192:195], v[80:95]
  ds_read_b128 v[40:43], v2 offset:22528
  s_waitcnt lgkmcnt(5)
  v_mfma_f32_32x32x16_bf16 v[80:95], v[52:55], v[196:199], v[80:95]
  ds_read_b128 v[44:47], v2 offset:23552
  s_waitcnt lgkmcnt(5)
  v_mfma_f32_32x32x16_bf16 v[80:95], v[56:59], v[200:203], v[80:95]
  ds_read_b128 v[48:51], v2 offset:24576
  s_waitcnt lgkmcnt(5)
  v_mfma_f32_32x32x16_bf16 v[80:95], v[60:63], v[204:207], v[80:95]
  ds_read_b128 v[52:55], v2 offset:25600
  s_waitcnt lgkmcnt(5)
  v_mfma_f32_32x32x16_bf16 v[80:95], v[32:35], v[208:211], v[80:95]
  ds_read_b128 v[56:59], v2 offset:26624
  s_waitcnt lgkmcnt(5)
  v_mfma_f32_32x32x16_bf16 v[80:95], v[36:39], v[212:215], v[80:95]
  ds_read_b128 v[60:63], v2 offset:27648
  s_waitcnt vmcnt(1)
  s_barrier
  s_waitcnt lgkmcnt(5)
  v_mfma_f32_32x32x16_bf16 v[80:95], v[40:43], v[216:219], v[80:95]
  ds_read_b128 v[32:35], v2 offset:28672
  s_waitcnt lgkmcnt(5)
  v_mfma_f32_32x32x16_bf16 v[80:95], v[44:47], v[220:223], v[80:95]
  ds_read_b128 v[36:39], v2 offset:29696
  s_waitcnt lgkmcnt(5)
  v_mfma_f32_32x32x16_bf16 v[80:95], v[48:51], v[224:227], v[80:95]
  ds_read_b128 v[40:43], v2 offset:30720
  s_waitcnt lgkmcnt(5)
  v_mfma_f32_32x32x16_bf16 v[80:95], v[52:55], v[228:231], v[80:95]
  ds_read_b128 v[44:47], v2 offset:31744
  s_waitcnt lgkmcnt(5)
  v_mfma_f32_32x32x16_bf16 v[80:95], v[56:59], v[232:235], v[80:95]
  ds_read_b128 v[48:51], v3 offset:12288
  s_waitcnt lgkmcnt(5)
  v_mfma_f32_32x32x16_bf16 v[80:95], v[60:63], v[236:239], v[80:95]
  ds_read_b128 v[52:55], v1 offset:0
  s_waitcnt lgkmcnt(5)
  v_mfma_f32_32x32x16_bf16 v[80:95], v[32:35], v[240:243], v[80:95]
  ds_read_b128 v[56:59], v1 offset:1024
  s_waitcnt lgkmcnt(5)
  v_mfma_f32_32x32x16_bf16 v[80:95], v[36:39], v[244:247], v[80:95]
  ds_read_b128 v[60:63], v1 offset:2048
  s_waitcnt lgkmcnt(5)
  v_mfma_f32_32x32x16_bf16 v[80:95], v[40:43], v[248:251], v[80:95]
  ds_read_b128 v[32:35], v1 offset:3072
  s_waitcnt lgkmcnt(5)
  v_mfma_f32_32x32x16_bf16 v[80:95], v[44:47], v[252:255], v[80:95]
  ds_read_b128 v[36:39], v1 offset:4096
  s_waitcnt lgkmcnt(5)
  v_mfma_f32_32x32x16_bf16 v[80:95], v[48:51], v[12:15], v[80:95]
  ds_read_b128 v[40:43], v1 offset:5120
  s_waitcnt lgkmcnt(5)
  v_mfma_f32_32x32x16_bf16 v[96:111], v[52:55], v[128:131], 0
  ds_read_b128 v[44:47], v1 offset:6144
  s_waitcnt lgkmcnt(5)
  v_mfma_f32_32x32x16_bf16 v[96:111], v[56:59], v[132:135], v[96:111]
  ds_read_b128 v[48:51], v1 offset:7168
  s_waitcnt vmcnt(0)
  s_mov_b32 s52, 1
  s_atomic_add s52, s[12:13], s54
  s_nop 1
  v_mul_f32 v80, v80, v88
  v_mul_f32 v80, v80, v10
  v_mul_f32_e64 v81, v81, v89
  s_waitcnt lgkmcnt(5)
  v_mfma_f32_32x32x16_bf16 v[96:111], v[60:63], v[136:139], v[96:111]
  ds_read_b128 v[52:55], v1 offset:8192
  v_mul_f32_e64 v81, v81, v10
  v_cvt_pk_bf16_f32 v88, v80, v81
  v_mul_f32 v82, v82, v90
  s_waitcnt lgkmcnt(5)
  v_mfma_f32_32x32x16_bf16 v[96:111], v[32:35], v[140:143], v[96:111]
  ds_read_b128 v[56:59], v1 offset:9216
  v_mul_f32 v82, v82, v10
  v_mul_f32 v83, v83, v91
  v_mul_f32 v83, v83, v10
  s_waitcnt lgkmcnt(5)
  v_mfma_f32_32x32x16_bf16 v[96:111], v[36:39], v[144:147], v[96:111]
  ds_read_b128 v[60:63], v1 offset:10240
  v_cvt_pk_bf16_f32 v89, v82, v83
  v_mul_f32 v84, v84, v92
  v_mul_f32_e64 v84, v84, v10
  s_waitcnt lgkmcnt(5)
  v_mfma_f32_32x32x16_bf16 v[96:111], v[40:43], v[148:151], v[96:111]
  ds_read_b128 v[32:35], v1 offset:11264
  v_mul_f32 v85, v85, v93
  v_mul_f32 v85, v85, v10
  v_cvt_pk_bf16_f32 v90, v84, v85
  s_waitcnt lgkmcnt(5)
  v_mfma_f32_32x32x16_bf16 v[96:111], v[44:47], v[152:155], v[96:111]
  ds_read_b128 v[36:39], v1 offset:12288
  v_mul_f32 v86, v86, v94
  v_mul_f32 v86, v86, v10
  v_mul_f32_e64 v87, v87, v95
  s_waitcnt lgkmcnt(5)
  v_mfma_f32_32x32x16_bf16 v[96:111], v[48:51], v[156:159], v[96:111]
  ds_read_b128 v[40:43], v1 offset:13312
  v_mul_f32_e64 v87, v87, v10
  v_cvt_pk_bf16_f32 v91, v86, v87
  s_add_u32 s53, s49, 4096
  buffer_store_dwordx4 v[88:91], v1, s[4:7], s53 offen offset:0 sc0 sc1
  s_waitcnt lgkmcnt(5)
  v_mfma_f32_32x32x16_bf16 v[96:111], v[52:55], v[160:163], v[96:111]
  ds_read_b128 v[44:47], v1 offset:14336
  s_waitcnt lgkmcnt(5)
  v_mfma_f32_32x32x16_bf16 v[96:111], v[56:59], v[164:167], v[96:111]
  ds_read_b128 v[48:51], v1 offset:15360
  s_waitcnt lgkmcnt(5)
  v_mfma_f32_32x32x16_bf16 v[96:111], v[60:63], v[168:171], v[96:111]
  ds_read_b128 v[52:55], v1 offset:16384
  s_waitcnt lgkmcnt(5)
  v_mfma_f32_32x32x16_bf16 v[96:111], v[32:35], v[172:175], v[96:111]
  ds_read_b128 v[56:59], v1 offset:17408
  s_waitcnt lgkmcnt(5)
  v_mfma_f32_32x32x16_bf16 v[96:111], v[36:39], v[176:179], v[96:111]
  ds_read_b128 v[60:63], v1 offset:18432
  s_waitcnt lgkmcnt(5)
  v_mfma_f32_32x32x16_bf16 v[96:111], v[40:43], v[180:183], v[96:111]
  ds_read_b128 v[32:35], v1 offset:19456
  s_waitcnt lgkmcnt(5)
  v_mfma_f32_32x32x16_bf16 v[96:111], v[44:47], v[184:187], v[96:111]
  ds_read_b128 v[36:39], v1 offset:20480
  s_waitcnt lgkmcnt(5)
  v_mfma_f32_32x32x16_bf16 v[96:111], v[48:51], v[188:191], v[96:111]
  ds_read_b128 v[40:43], v1 offset:21504
  s_waitcnt lgkmcnt(5)
  v_mfma_f32_32x32x16_bf16 v[96:111], v[52:55], v[192:195], v[96:111]
  ds_read_b128 v[44:47], v1 offset:22528
  s_waitcnt lgkmcnt(5)
  v_mfma_f32_32x32x16_bf16 v[96:111], v[56:59], v[196:199], v[96:111]
  ds_read_b128 v[48:51], v1 offset:23552
  s_waitcnt lgkmcnt(5)
  v_mfma_f32_32x32x16_bf16 v[96:111], v[60:63], v[200:203], v[96:111]
  ds_read_b128 v[52:55], v1 offset:24576
  s_waitcnt lgkmcnt(5)
  v_mfma_f32_32x32x16_bf16 v[96:111], v[32:35], v[204:207], v[96:111]
  ds_read_b128 v[56:59], v1 offset:25600
  s_waitcnt lgkmcnt(5)
  v_mfma_f32_32x32x16_bf16 v[96:111], v[36:39], v[208:211], v[96:111]
  ds_read_b128 v[60:63], v1 offset:26624
  s_waitcnt lgkmcnt(5)
  v_mfma_f32_32x32x16_bf16 v[96:111], v[40:43], v[212:215], v[96:111]
  ds_read_b128 v[32:35], v1 offset:27648
  s_waitcnt lgkmcnt(5)
  v_mfma_f32_32x32x16_bf16 v[96:111], v[44:47], v[216:219], v[96:111]
  ds_read_b128 v[36:39], v1 offset:28672
  s_waitcnt lgkmcnt(5)
  v_mfma_f32_32x32x16_bf16 v[96:111], v[48:51], v[220:223], v[96:111]
  ds_read_b128 v[40:43], v1 offset:29696
  s_waitcnt lgkmcnt(5)
  v_mfma_f32_32x32x16_bf16 v[96:111], v[52:55], v[224:227], v[96:111]
  ds_read_b128 v[44:47], v1 offset:30720
  s_waitcnt lgkmcnt(5)
  v_mfma_f32_32x32x16_bf16 v[96:111], v[56:59], v[228:231], v[96:111]
  ds_read_b128 v[48:51], v1 offset:31744
  s_waitcnt lgkmcnt(5)
  v_mfma_f32_32x32x16_bf16 v[96:111], v[60:63], v[232:235], v[96:111]
  ds_read_b128 v[52:55], v3 offset:13312
  s_waitcnt lgkmcnt(5)
  v_mfma_f32_32x32x16_bf16 v[96:111], v[32:35], v[236:239], v[96:111]
  ds_read_b128 v[56:59], v1 offset:32768
  s_waitcnt lgkmcnt(5)
  v_mfma_f32_32x32x16_bf16 v[96:111], v[36:39], v[240:243], v[96:111]
  ds_read_b128 v[60:63], v1 offset:33792
  s_waitcnt lgkmcnt(5)
  v_mfma_f32_32x32x16_bf16 v[96:111], v[40:43], v[244:247], v[96:111]
  ds_read_b128 v[32:35], v1 offset:34816
  s_waitcnt lgkmcnt(5)
  v_mfma_f32_32x32x16_bf16 v[96:111], v[44:47], v[248:251], v[96:111]
  ds_read_b128 v[36:39], v1 offset:35840
  s_waitcnt lgkmcnt(5)
  v_mfma_f32_32x32x16_bf16 v[96:111], v[48:51], v[252:255], v[96:111]
  ds_read_b128 v[40:43], v1 offset:36864
  s_waitcnt lgkmcnt(5)
  v_mfma_f32_32x32x16_bf16 v[96:111], v[52:55], v[12:15], v[96:111]
  ds_read_b128 v[44:47], v1 offset:37888
L32:
  s_waitcnt lgkmcnt(5)
  v_mfma_f32_32x32x16_bf16 v[64:79], v[56:59], v[128:131], 0
  ds_read_b128 v[48:51], v1 offset:38912
  s_mov_b32 s60, 0
  s_mov_b32 s61, 0
  s_atomic_add s60, s[12:13], s57 glc
  s_atomic_add s61, s[12:13], s55 glc
  s_waitcnt lgkmcnt(5)
  v_mfma_f32_32x32x16_bf16 v[64:79], v[60:63], v[132:135], v[64:79]
  ds_read_b128 v[52:55], v1 offset:39936
  s_nop 0
  v_mul_f32 v96, v96, v104
  v_mul_f32 v96, v96, v10
  v_mul_f32 v97, v97, v105
  s_waitcnt lgkmcnt(5)
  v_mfma_f32_32x32x16_bf16 v[64:79], v[32:35], v[136:139], v[64:79]
  ds_read_b128 v[56:59], v1 offset:40960
  v_mul_f32_e64 v97, v97, v10
  v_cvt_pk_bf16_f32 v104, v96, v97
  v_mul_f32 v98, v98, v106
  s_waitcnt lgkmcnt(5)
  v_mfma_f32_32x32x16_bf16 v[64:79], v[36:39], v[140:143], v[64:79]
  ds_read_b128 v[60:63], v1 offset:41984
  v_mul_f32 v98, v98, v10
  v_mul_f32 v99, v99, v107
  v_mul_f32 v99, v99, v10
  s_waitcnt lgkmcnt(5)
  v_mfma_f32_32x32x16_bf16 v[64:79], v[40:43], v[144:147], v[64:79]
  ds_read_b128 v[32:35], v1 offset:43008
  v_cvt_pk_bf16_f32 v105, v98, v99
  v_mul_f32 v100, v100, v108
  v_mul_f32_e64 v100, v100, v10
  s_waitcnt lgkmcnt(5)
  v_mfma_f32_32x32x16_bf16 v[64:79], v[44:47], v[148:151], v[64:79]
  ds_read_b128 v[36:39], v1 offset:44032
  v_mul_f32 v101, v101, v109
  v_mul_f32 v101, v101, v10
  v_cvt_pk_bf16_f32 v106, v100, v101
  s_waitcnt lgkmcnt(5)
  v_mfma_f32_32x32x16_bf16 v[64:79], v[48:51], v[152:155], v[64:79]
  ds_read_b128 v[40:43], v1 offset:45056
  v_mul_f32 v102, v102, v110
  v_mul_f32 v102, v102, v10
  v_mul_f32_e64 v103, v103, v111
  s_waitcnt lgkmcnt(5)
  v_mfma_f32_32x32x16_bf16 v[64:79], v[52:55], v[156:159], v[64:79]
  ds_read_b128 v[44:47], v1 offset:46080
  v_mul_f32_e64 v103, v103, v10
  v_cvt_pk_bf16_f32 v107, v102, v103
  s_add_u32 s53, s49, 4096
  buffer_store_dwordx4 v[104:107], v1, s[4:7], s53 offen offset:1024 sc0 sc1
  s_waitcnt lgkmcnt(0)
  s_and_b32 s60, s60, 15
  s_and_b32 s61, s61, 15
  s_min_u32 s60, s60, s61
  s_cmp_ge_u32 s60, 4
  s_cbranch_scc1 PD33
  s_mov_b32 s50, 0
PL34:
  s_mov_b32 s51, 0
  s_atomic_add s51, s[12:13], s57 glc
  s_waitcnt lgkmcnt(0)
  s_and_b32 s51, s51, 15
  s_cmp_ge_u32 s51, 4
  s_cbranch_scc1 PD35
  s_add_u32 s50, s50, 1
  s_cmp_lt_u32 s50, 20000
  s_cbranch_scc1 PL34
PD35:
  s_mov_b32 s50, 0
PL36:
  s_mov_b32 s51, 0
  s_atomic_add s51, s[12:13], s55 glc
  s_waitcnt lgkmcnt(0)
  s_and_b32 s51, s51, 15
  s_cmp_ge_u32 s51, 4
  s_cbranch_scc1 PD37
  s_add_u32 s50, s50, 1
  s_cmp_lt_u32 s50, 20000
  s_cbranch_scc1 PL36
PD37:
PD33:
  v_mfma_f32_32x32x16_bf16 v[64:79], v[56:59], v[160:163], v[64:79]
  ds_read_b128 v[48:51], v1 offset:47104
  buffer_load_dwordx4 v[128:131], v1, s[4:7], s56 offen offset:0 sc1
  v_mfma_f32_32x32x16_bf16 v[64:79], v[60:63], v[164:167], v[64:79]
  ds_read_b128 v[52:55], v1 offset:48128
  v_mfma_f32_32x32x16_bf16 v[64:79], v[32:35], v[168:171], v[64:79]
  ds_read_b128 v[56:59], v1 offset:49152
  s_add_u32 s48, s56, 4096
  buffer_load_dwordx4 v[132:135], v1, s[4:7], s48 offen offset:3072 sc1
  v_mfma_f32_32x32x16_bf16 v[64:79], v[36:39], v[172:175], v[64:79]
  ds_read_b128 v[60:63], v1 offset:50176
  v_mfma_f32_32x32x16_bf16 v[64:79], v[40:43], v[176:179], v[64:79]
  ds_read_b128 v[32:35], v1 offset:51200
  s_add_u32 s48, s56, 12288
  buffer_load_dwordx4 v[136:139], v1, s[4:7], s48 offen offset:2048 sc1
  v_mfma_f32_32x32x16_bf16 v[64:79], v[44:47], v[180:183], v[64:79]
  ds_read_b128 v[36:39], v1 offset:52224
  s_waitcnt lgkmcnt(5)
  v_mfma_f32_32x32x16_bf16 v[64:79], v[48:51], v[184:187], v[64:79]
  ds_read_b128 v[40:43], v1 offset:53248
  s_add_u32 s48, s56, 20480
  buffer_load_dwordx4 v[140:143], v1, s[4:7], s48 offen offset:1024 sc1
  s_waitcnt lgkmcnt(5)
  v_mfma_f32_32x32x16_bf16 v[64:79], v[52:55], v[188:191], v[64:79]
  ds_read_b128 v[44:47], v1 offset:54272
  s_waitcnt lgkmcnt(5)
  v_mfma_f32_32x32x16_bf16 v[64:79], v[56:59], v[192:195], v[64:79]
  ds_read_b128 v[48:51], v1 offset:55296
  buffer_load_dwordx4 v[144:147], v1, s[4:7], s56 offen offset:1024 sc1
  s_waitcnt lgkmcnt(5)
  v_mfma_f32_32x32x16_bf16 v[64:79], v[60:63], v[196:199], v[64:79]
  ds_read_b128 v[52:55], v1 offset:56320
  s_waitcnt lgkmcnt(5)
  v_mfma_f32_32x32x16_bf16 v[64:79], v[32:35], v[200:203], v[64:79]
  ds_read_b128 v[56:59], v1 offset:57344
  s_add_u32 s48, s56, 8192
  buffer_load_dwordx4 v[148:151], v1, s[4:7], s48 offen offset:0 sc1
  s_waitcnt lgkmcnt(5)
  v_mfma_f32_32x32x16_bf16 v[64:79], v[36:39], v[204:207], v[64:79]
  ds_read_b128 v[60:63], v1 offset:58368
  s_waitcnt lgkmcnt(5)
  v_mfma_f32_32x32x16_bf16 v[64:79], v[40:43], v[208:211], v[64:79]
  ds_read_b128 v[32:35], v1 offset:59392
  s_add_u32 s48, s56, 12288
  buffer_load_dwordx4 v[152:155], v1, s[4:7], s48 offen offset:3072 sc1
  s_waitcnt lgkmcnt(5)
  v_mfma_f32_32x32x16_bf16 v[64:79], v[44:47], v[212:215], v[64:79]
  ds_read_b128 v[36:39], v1 offset:60416
  s_waitcnt lgkmcnt(5)
  v_mfma_f32_32x32x16_bf16 v[64:79], v[48:51], v[216:219], v[64:79]
  ds_read_b128 v[40:43], v1 offset:61440
  s_add_u32 s48, s56, 20480
  buffer_load_dwordx4 v[156:159], v1, s[4:7], s48 offen offset:2048 sc1
  s_waitcnt lgkmcnt(5)
  v_mfma_f32_32x32x16_bf16 v[64:79], v[52:55], v[220:223], v[64:79]
  ds_read_b128 v[44:47], v1 offset:62464
  s_waitcnt lgkmcnt(5)
  v_mfma_f32_32x32x16_bf16 v[64:79], v[56:59], v[224:227], v[64:79]
  ds_read_b128 v[48:51], v1 offset:63488
  buffer_load_dwordx4 v[160:163], v1, s[4:7], s56 offen offset:2048 sc1
  s_waitcnt lgkmcnt(5)
  v_mfma_f32_32x32x16_bf16 v[64:79], v[60:63], v[228:231], v[64:79]
  ds_read_b128 v[52:55], v1 offset:64512
  s_waitcnt lgkmcnt(5)
  v_mfma_f32_32x32x16_bf16 v[64:79], v[32:35], v[232:235], v[64:79]
  ds_read_b128 v[56:59], v3 offset:14336
  s_add_u32 s48, s56, 8192
  buffer_load_dwordx4 v[164:167], v1, s[4:7], s48 offen offset:1024 sc1
  s_waitcnt lgkmcnt(5)
  v_mfma_f32_32x32x16_bf16 v[64:79], v[36:39], v[236:239], v[64:79]
  s_waitcnt lgkmcnt(4)
  v_mfma_f32_32x32x16_bf16 v[64:79], v[40:43], v[240:243], v[64:79]
  s_add_u32 s48, s56, 16384
  buffer_load_dwordx4 v[168:171], v1, s[4:7], s48 offen offset:0 sc1
  s_waitcnt lgkmcnt(3)
  v_mfma_f32_32x32x16_bf16 v[64:79], v[44:47], v[244:247], v[64:79]
  s_waitcnt lgkmcnt(2)
  v_mfma_f32_32x32x16_bf16 v[64:79], v[48:51], v[248:251], v[64:79]
  s_add_u32 s48, s56, 20480
  buffer_load_dwordx4 v[172:175], v1, s[4:7], s48 offen offset:3072 sc1
  s_waitcnt lgkmcnt(1)
  v_mfma_f32_32x32x16_bf16 v[64:79], v[52:55], v[252:255], v[64:79]
  s_waitcnt lgkmcnt(0)
  v_mfma_f32_32x32x16_bf16 v[64:79], v[56:59], v[12:15], v[64:79]
  s_waitcnt vmcnt(12)
  s_mov_b32 s52, 16
  s_atomic_add s52, s[12:13], s54
  s_nop 8
  v_mul_f32 v64, v64, v72
  v_mul_f32_e64 v64, v64, v10
  s_waitcnt vmcnt(11)
  v_mfma_f32_32x32x16_bf16 v[96:111], a[0:3], v[128:131], 0
  v_mul_f32 v65, v65, v73
  v_mul_f32 v65, v65, v10
  v_cvt_pk_bf16_f32 v72, v64, v65
  v_mul_f32 v66, v66, v74
  v_mul_f32 v66, v66, v10
  buffer_load_dwordx4 v[176:179], v1, s[4:7], s56 offen offset:3072 sc1
  v_mfma_f32_32x32x16_bf16 v[112:127], a[4:7], v[128:131], 0
  v_mul_f32 v67, v67, v75
  v_mul_f32 v67, v67, v10
  v_cvt_pk_bf16_f32 v73, v66, v67
  v_mul_f32 v68, v68, v76
  v_mul_f32_e64 v68, v68, v10
  s_waitcnt vmcnt(11)
  v_mfma_f32_32x32x16_bf16 v[96:111], a[56:59], v[132:135], v[96:111]
  v_mul_f32 v69, v69, v77
  v_mul_f32 v69, v69, v10
  v_cvt_pk_bf16_f32 v74, v68, v69
  v_mul_f32 v70, v70, v78
  v_mul_f32 v70, v70, v10
  s_add_u32 s48, s56, 8192
  buffer_load_dwordx4 v[180:183], v1, s[4:7], s48 offen offset:2048 sc1
  v_mfma_f32_32x32x16_bf16 v[112:127], a[60:63], v[132:135], v[112:127]
  v_mul_f32 v71, v71, v79
  v_mul_f32 v71, v71, v10
  v_cvt_pk_bf16_f32 v75, v70, v71
  buffer_store_dwordx4 v[72:75], v1, s[4:7], s53 offen offset:2048 sc0 sc1
  s_waitcnt vmcnt(12)
  v_mfma_f32_32x32x16_bf16 v[96:111], a[112:115], v[136:139], v[96:111]
  s_add_u32 s48, s56, 16384
  buffer_load_dwordx4 v[184:187], v1, s[4:7], s48 offen offset:1024 sc1
  v_mfma_f32_32x32x16_bf16 v[112:127], a[116:119], v[136:139], v[112:127]
  s_waitcnt vmcnt(12)
  v_mfma_f32_32x32x16_bf16 v[96:111], a[168:171], v[140:143], v[96:111]
  s_add_u32 s48, s56, 24576
  buffer_load_dwordx4 v[188:191], v1, s[4:7], s48 offen offset:0 sc1
  v_mfma_f32_32x32x16_bf16 v[112:127], a[172:175], v[140:143], v[112:127]
  s_waitcnt vmcnt(12)
  v_mfma_f32_32x32x16_bf16 v[96:111], a[8:11], v[144:147], v[96:111]
  s_add_u32 s48, s56, 114688
  buffer_load_dwordx4 v[192:195], v1, s[4:7], s48 offen offset:0 sc1
  v_mfma_f32_32x32x16_bf16 v[112:127], a[12:15], v[144:147], v[112:127]
  s_waitcnt vmcnt(12)
  v_mfma_f32_32x32x16_bf16 v[96:111], a[64:67], v[148:151], v[96:111]
  s_add_u32 s48, s56, 118784
  buffer_load_dwordx4 v[196:199], v1, s[4:7], s48 offen offset:3072 sc1
  v_mfma_f32_32x32x16_bf16 v[112:127], a[68:71], v[148:151], v[112:127]
  s_add_u32 s48, s56, 126976
  buffer_load_dwordx4 v[200:203], v1, s[4:7], s48 offen offset:2048 sc1
  s_mov_b32 s60, 0
  s_mov_b32 s61, 0
  s_atomic_add s60, s[12:13], s57 glc
  s_atomic_add s61, s[12:13], s57 glc
  s_waitcnt vmcnt(13)
  v_mfma_f32_32x32x16_bf16 v[96:111], a[120:123], v[152:155], v[96:111]
  s_add_u32 s48, s56, 135168
  buffer_load_dwordx4 v[204:207], v1, s[4:7], s48 offen offset:1024 sc1
  v_mfma_f32_32x32x16_bf16 v[112:127], a[124:127], v[152:155], v[112:127]
  s_waitcnt vmcnt(13)
  v_mfma_f32_32x32x16_bf16 v[96:111], a[176:179], v[156:159], v[96:111]
  s_add_u32 s48, s56, 114688
  buffer_load_dwordx4 v[208:211], v1, s[4:7], s48 offen offset:1024 sc1
  v_mfma_f32_32x32x16_bf16 v[112:127], a[180:183], v[156:159], v[112:127]
  s_waitcnt vmcnt(13)
  v_mfma_f32_32x32x16_bf16 v[96:111], a[16:19], v[160:163], v[96:111]
  s_add_u32 s48, s56, 122880
  buffer_load_dwordx4 v[212:215], v1, s[4:7], s48 offen offset:0 sc1
  v_mfma_f32_32x32x16_bf16 v[112:127], a[20:23], v[160:163], v[112:127]
  s_waitcnt vmcnt(8)
  s_mov_b32 s52, 256
  s_atomic_add s52, s[12:13], s54
  s_add_u32 s48, s56, 126976
  buffer_load_dwordx4 v[216:219], v1, s[4:7], s48 offen offset:3072 sc1
  v_mfma_f32_32x32x16_bf16 v[96:111], a[72:75], v[164:167], v[96:111]
  v_mfma_f32_32x32x16_bf16 v[112:127], a[76:79], v[164:167], v[112:127]
  s_add_u32 s48, s56, 135168
  buffer_load_dwordx4 v[220:223], v1, s[4:7], s48 offen offset:2048 sc1
  v_mfma_f32_32x32x16_bf16 v[96:111], a[128:131], v[168:171], v[96:111]
  v_mfma_f32_32x32x16_bf16 v[112:127], a[132:135], v[168:171], v[112:127]
  s_waitcnt lgkmcnt(0)
  s_and_b32 s60, s60, 240
  s_and_b32 s61, s61, 240
  s_min_u32 s60, s60, s61
  s_cmp_ge_u32 s60, 64
  s_cbranch_scc1 PD38
  s_mov_b32 s50, 0
PL39:
  s_mov_b32 s51, 0
  s_atomic_add s51, s[12:13], s57 glc
  s_waitcnt lgkmcnt(0)
  s_and_b32 s51, s51, 240
  s_cmp_ge_u32 s51, 64
  s_cbranch_scc1 PD40
  s_add_u32 s50, s50, 1
  s_cmp_lt_u32 s50, 20000
  s_cbranch_scc1 PL39
PD40:
  s_mov_b32 s50, 0
PL41:
  s_mov_b32 s51, 0
  s_atomic_add s51, s[12:13], s57 glc
  s_waitcnt lgkmcnt(0)
  s_and_b32 s51, s51, 240
  s_cmp_ge_u32 s51, 64
  s_cbranch_scc1 PD42
  s_add_u32 s50, s50, 1
  s_cmp_lt_u32 s50, 20000
  s_cbranch_scc1 PL41
PD42:
PD38:
  v_mfma_f32_32x32x16_bf16 v[96:111], a[184:187], v[172:175], v[96:111]
  s_add_u32 s48, s56, 4096
  buffer_load_dwordx4 v[224:227], v1, s[4:7], s48 offen offset:0 sc1
  v_mfma_f32_32x32x16_bf16 v[112:127], a[188:191], v[172:175], v[112:127]
  v_mfma_f32_32x32x16_bf16 v[96:111], a[24:27], v[176:179], v[96:111]
  s_add_u32 s48, s56, 8192
  buffer_load_dwordx4 v[228:231], v1, s[4:7], s48 offen offset:3072 sc1
  v_mfma_f32_32x32x16_bf16 v[112:127], a[28:31], v[176:179], v[112:127]
  v_mfma_f32_32x32x16_bf16 v[96:111], a[80:83], v[180:183], v[96:111]
  s_add_u32 s48, s56, 16384
  buffer_load_dwordx4 v[232:235], v1, s[4:7], s48 offen offset:2048 sc1
  v_mfma_f32_32x32x16_bf16 v[112:127], a[84:87], v[180:183], v[112:127]
  s_waitcnt vmcnt(12)
  v_mfma_f32_32x32x16_bf16 v[96:111], a[136:139], v[184:187], v[96:111]
  s_add_u32 s48, s56, 24576
  buffer_load_dwordx4 v[236:239], v1, s[4:7], s48 offen offset:1024 sc1
  v_mfma_f32_32x32x16_bf16 v[112:127], a[140:143], v[184:187], v[112:127]
  s_mov_b32 s60, 0
  s_mov_b32 s61, 0
  s_atomic_add s60, s[12:13], s57 glc
  s_atomic_add s61, s[12:13], s55 glc
  s_add_u32 s48, s56, 4096
  buffer_load_dwordx4 v[240:243], v1, s[4:7], s48 offen offset:1024 sc1
  s_waitcnt vmcnt(13)
  v_mfma_f32_32x32x16_bf16 v[96:111], a[192:195], v[188:191], v[96:111]
  v_mfma_f32_32x32x16_bf16 v[112:127], a[196:199], v[188:191], v[112:127]
  s_add_u32 s48, s56, 12288
  buffer_load_dwordx4 v[244:247], v1, s[4:7], s48 offen offset:0 sc1
  s_waitcnt vmcnt(13)
  v_mfma_f32_32x32x16_bf16 v[64:79], a[0:3], v[192:195], 0
  s_add_u32 s48, s56, 16384
  buffer_load_dwordx4 v[248:251], v1, s[4:7], s48 offen offset:3072 sc1
  v_mfma_f32_32x32x16_bf16 v[80:95], a[4:7], v[192:195], 0
  s_waitcnt vmcnt(13)
  v_mfma_f32_32x32x16_bf16 v[64:79], a[56:59], v[196:199], v[64:79]
  s_add_u32 s48, s56, 24576
  buffer_load_dwordx4 v[252:255], v1, s[4:7], s48 offen offset:2048 sc1
  v_mfma_f32_32x32x16_bf16 v[80:95], a[60:63], v[196:199], v[80:95]
  s_waitcnt vmcnt(13)
  v_mfma_f32_32x32x16_bf16 v[64:79], a[112:115], v[200:203], v[64:79]
  v_mfma_f32_32x32x16_bf16 v[80:95], a[116:119], v[200:203], v[80:95]
  s_waitcnt vmcnt(12)
  v_mfma_f32_32x32x16_bf16 v[64:79], a[168:171], v[204:207], v[64:79]
  v_mfma_f32_32x32x16_bf16 v[80:95], a[172:175], v[204:207], v[80:95]
  s_waitcnt lgkmcnt(0)
  s_min_u32 s60, s60, s61
  s_cmp_ge_u32 s60, 1024
  s_cbranch_scc1 PD43
  s_mov_b32 s50, 0
PL44:
  s_mov_b32 s51, 0
  s_atomic_add s51, s[12:13], s57 glc
  s_waitcnt lgkmcnt(0)
  s_cmp_ge_u32 s51, 1024
  s_cbranch_scc1 PD45
  s_add_u32 s50, s50, 1
  s_cmp_lt_u32 s50, 20000
  s_cbranch_scc1 PL44
PD45:
  s_mov_b32 s50, 0
PL46:
  s_mov_b32 s51, 0
  s_atomic_add s51, s[12:13], s55 glc
  s_waitcnt lgkmcnt(0)
  s_cmp_ge_u32 s51, 1024
  s_cbranch_scc1 PD47
  s_add_u32 s50, s50, 1
  s_cmp_lt_u32 s50, 20000
  s_cbranch_scc1 PL46
PD47:
PD43:
  s_waitcnt vmcnt(11)
  v_mfma_f32_32x32x16_bf16 v[64:79], a[8:11], v[208:211], v[64:79]
  s_add_u32 s48, s56, 4096
  buffer_load_dwordx4 v[128:131], v1, s[4:7], s48 offen offset:2048 sc1
  v_mfma_f32_32x32x16_bf16 v[80:95], a[12:15], v[208:211], v[80:95]
  s_waitcnt vmcnt(11)
  v_mfma_f32_32x32x16_bf16 v[64:79], a[64:67], v[212:215], v[64:79]
  s_add_u32 s48, s56, 12288
  buffer_load_dwordx4 v[132:135], v1, s[4:7], s48 offen offset:1024 sc1
  v_mfma_f32_32x32x16_bf16 v[80:95], a[68:71], v[212:215], v[80:95]
  s_waitcnt vmcnt(11)
  v_mfma_f32_32x32x16_bf16 v[64:79], a[120:123], v[216:219], v[64:79]
  s_add_u32 s48, s56, 20480
  buffer_load_dwordx4 v[136:139], v1, s[4:7], s48 offen offset:0 sc1
  v_mfma_f32_32x32x16_bf16 v[80:95], a[124:127], v[216:219], v[80:95]
  s_waitcnt vmcnt(11)
  v_mfma_f32_32x32x16_bf16 v[64:79], a[176:179], v[220:223], v[64:79]
  s_add_u32 s48, s56, 24576
  buffer_load_dwordx4 v[140:143], v1, s[4:7], s48 offen offset:3072 sc1
  v_mfma_f32_32x32x16_bf16 v[80:95], a[180:183], v[220:223], v[80:95]
  s_waitcnt vmcnt(11)
  v_mfma_f32_32x32x16_bf16 v[96:111], a[32:35], v[224:227], v[96:111]
  s_add_u32 s48, s56, 114688
  buffer_load_dwordx4 v[144:147], v1, s[4:7], s48 offen offset:2048 sc1
  v_mfma_f32_32x32x16_bf16 v[112:127], a[36:39], v[224:227], v[112:127]
  s_waitcnt vmcnt(11)
  v_mfma_f32_32x32x16_bf16 v[96:111], a[88:91], v[228:231], v[96:111]
  s_add_u32 s48, s56, 122880
  buffer_load_dwordx4 v[148:151], v1, s[4:7], s48 offen offset:1024 sc1
  v_mfma_f32_32x32x16_bf16 v[112:127], a[92:95], v[228:231], v[112:127]
  s_add_u32 s48, s56, 131072
  buffer_load_dwordx4 v[152:155], v1, s[4:7], s48 offen offset:0 sc1
  s_waitcnt vmcnt(12)
  v_mfma_f32_32x32x16_bf16 v[96:111], a[144:147], v[232:235], v[96:111]
  v_mfma_f32_32x32x16_bf16 v[112:127], a[148:151], v[232:235], v[112:127]
  s_add_u32 s48, s56, 135168
  buffer_load_dwordx4 v[156:159], v1, s[4:7], s48 offen offset:3072 sc1
  s_waitcnt vmcnt(12)
  v_mfma_f32_32x32x16_bf16 v[96:111], a[200:203], v[236:239], v[96:111]
  v_mfma_f32_32x32x16_bf16 v[112:127], a[204:207], v[236:239], v[112:127]
  s_add_u32 s48, s56, 114688
  buffer_load_dwordx4 v[160:163], v1, s[4:7], s48 offen offset:3072 sc1
  s_waitcnt vmcnt(12)
  v_mfma_f32_32x32x16_bf16 v[96:111], a[40:43], v[240:243], v[96:111]
  v_mfma_f32_32x32x16_bf16 v[112:127], a[44:47], v[240:243], v[112:127]
  s_add_u32 s48, s56, 122880
  buffer_load_dwordx4 v[164:167], v1, s[4:7], s48 offen offset:2048 sc1
  s_waitcnt vmcnt(12)
  v_mfma_f32_32x32x16_bf16 v[96:111], a[96:99], v[244:247], v[96:111]
  v_mfma_f32_32x32x16_bf16 v[112:127], a[100:103], v[244:247], v[112:127]
  s_add_u32 s48, s56, 131072
  buffer_load_dwordx4 v[168:171], v1, s[4:7], s48 offen offset:1024 sc1
  s_waitcnt vmcnt(12)
  v_mfma_f32_32x32x16_bf16 v[96:111], a[152:155], v[248:251], v[96:111]
  v_mfma_f32_32x32x16_bf16 v[112:127], a[156:159], v[248:251], v[112:127]
  s_add_u32 s48, s56, 139264
  buffer_load_dwordx4 v[172:175], v1, s[4:7], s48 offen offset:0 sc1
  s_waitcnt vmcnt(12)
  v_mfma_f32_32x32x16_bf16 v[96:111], a[208:211], v[252:255], v[96:111]
  v_mfma_f32_32x32x16_bf16 v[112:127], a[212:215], v[252:255], v[112:127]
  s_add_u32 s48, s56, 118784
  buffer_load_dwordx4 v[176:179], v1, s[4:7], s48 offen offset:0 sc1
  s_waitcnt vmcnt(12)
  v_mfma_f32_32x32x16_bf16 v[96:111], a[48:51], v[128:131], v[96:111]
  s_add_u32 s48, s56, 122880
  buffer_load_dwordx4 v[180:183], v1, s[4:7], s48 offen offset:3072 sc1
  v_mfma_f32_32x32x16_bf16 v[112:127], a[52:55], v[128:131], v[112:127]
  s_waitcnt vmcnt(12)
  v_mfma_f32_32x32x16_bf16 v[96:111], a[104:107], v[132:135], v[96:111]
  s_add_u32 s48, s56, 131072
  buffer_load_dwordx4 v[184:187], v1, s[4:7], s48 offen offset:2048 sc1
  v_mfma_f32_32x32x16_bf16 v[112:127], a[108:111], v[132:135], v[112:127]
  s_waitcnt vmcnt(12)
  v_mfma_f32_32x32x16_bf16 v[96:111], a[160:163], v[136:139], v[96:111]
  s_add_u32 s48, s56, 139264
  buffer_load_dwordx4 v[188:191], v1, s[4:7], s48 offen offset:1024 sc1
  v_mfma_f32_32x32x16_bf16 v[112:127], a[164:167], v[136:139], v[112:127]
  s_waitcnt vmcnt(12)
  v_mfma_f32_32x32x16_bf16 v[96:111], a[216:219], v[140:143], v[96:111]
  s_add_u32 s48, s56, 118784
  buffer_load_dwordx4 v[192:195], v1, s[4:7], s48 offen offset:1024 sc1
  v_mfma_f32_32x32x16_bf16 v[112:127], a[220:223], v[140:143], v[112:127]
  s_cmp_eq_u32 s15, 0
  s_cselect_b32 s26, s25, 0x70000000
  s_cselect_b32 s41, s37, 0x70000000
  s_lshl_b32 s44, s19, 16
  s_add_u32 s44, s44, s22
  s_lshl_b32 s45, s20, 7
  s_add_u32 s44, s44, s45
  s_cmp_eq_u32 s15, 0
  s_cselect_b32 s43, 0x70000000, s44
  s_barrier
  s_waitcnt vmcnt(12)
  v_mfma_f32_32x32x16_bf16 v[64:79], a[16:19], v[144:147], v[64:79]
  v_mfma_f32_32x32x16_bf16 v[80:95], a[20:23], v[144:147], v[80:95]
  s_add_u32 s48, s56, 126976
  buffer_load_dwordx4 v[196:199], v1, s[4:7], s48 offen offset:0 sc1
  s_waitcnt vmcnt(12)
  v_mfma_f32_32x32x16_bf16 v[64:79], a[72:75], v[148:151], v[64:79]
  s_add_u32 s48, s56, 131072
  buffer_load_dwordx4 v[200:203], v1, s[4:7], s48 offen offset:3072 sc1
  v_mfma_f32_32x32x16_bf16 v[80:95], a[76:79], v[148:151], v[80:95]
  s_add_u32 s44, s22, 65536
  v_add_u32 v28, s44, v1
  s_waitcnt vmcnt(12)
  v_mfma_f32_32x32x16_bf16 v[64:79], a[128:131], v[152:155], v[64:79]
  s_add_u32 s48, s56, 139264
  buffer_load_dwordx4 v[204:207], v1, s[4:7], s48 offen offset:2048 sc1
  v_mfma_f32_32x32x16_bf16 v[80:95], a[132:135], v[152:155], v[80:95]
  s_add_u32 s48, s56, 118784
  buffer_load_dwordx4 v[208:211], v1, s[4:7], s48 offen offset:2048 sc1
  v_xor_b32 v29, 0x80, v28
  s_waitcnt vmcnt(13)
  v_mfma_f32_32x32x16_bf16 v[64:79], a[184:187], v[156:159], v[64:79]
  ds_write_b128 v28, v[96:99] offset:0
  v_mfma_f32_32x32x16_bf16 v[80:95], a[188:191], v[156:159], v[80:95]
  s_add_u32 s48, s56, 126976
  buffer_load_dwordx4 v[212:215], v1, s[4:7], s48 offen offset:1024 sc1
  ds_write_b128 v28, v[100:103] offset:1024
  s_waitcnt vmcnt(13)
  v_mfma_f32_32x32x16_bf16 v[64:79], a[24:27], v[160:163], v[64:79]
  s_add_u32 s48, s56, 135168
  buffer_load_dwordx4 v[216:219], v1, s[4:7], s48 offen offset:0 sc1
  ds_write_b128 v28, v[104:107] offset:2048
  v_mfma_f32_32x32x16_bf16 v[80:95], a[28:31], v[160:163], v[80:95]
  s_add_u32 s48, s56, 139264
  buffer_load_dwordx4 v[220:223], v1, s[4:7], s48 offen offset:3072 sc1
  ds_write_b128 v28, v[108:111] offset:3072
  s_waitcnt vmcnt(14)
  v_mfma_f32_32x32x16_bf16 v[64:79], a[80:83], v[164:167], v[64:79]
  ds_write_b128 v29, v[112:115] offset:4096
  v_mfma_f32_32x32x16_bf16 v[80:95], a[84:87], v[164:167], v[80:95]
  s_add_u32 m0, s22, 0
  s_nop 0
  buffer_load_dwordx4 v1, s[4:7], s26 offen offset:0 sc1 lds
  ds_write_b128 v29, v[116:119] offset:5120
  s_waitcnt vmcnt(14)
  v_mfma_f32_32x32x16_bf16 v[64:79], a[136:139], v[168:171], v[64:79]
  buffer_load_dwordx4 v1, s[4:7], s26 offen offset:1024 sc1 lds
  ds_write_b128 v29, v[120:123] offset:6144
  v_mfma_f32_32x32x16_bf16 v[80:95], a[140:143], v[168:171], v[80:95]
  ds_write_b128 v29, v[124:127] offset:7168
  s_waitcnt vmcnt(14)
  v_mfma_f32_32x32x16_bf16 v[64:79], a[192:195], v[172:175], v[64:79]
  buffer_load_dwordx4 v1, s[4:7], s26 offen offset:2048 sc1 lds
  v_mfma_f32_32x32x16_bf16 v[80:95], a[196:199], v[172:175], v[80:95]
  buffer_load_dwordx4 v1, s[4:7], s26 offen offset:3072 sc1 lds
  s_waitcnt vmcnt(15)
  v_mfma_f32_32x32x16_bf16 v[64:79], a[32:35], v[176:179], v[64:79]
  v_mfma_f32_32x32x16_bf16 v[80:95], a[36:39], v[176:179], v[80:95]
  s_add_u32 s46, s26, 4096
  s_add_u32 m0, s22, 4096
  s_nop 0
  buffer_load_dwordx4 v1, s[4:7], s46 offen offset:0 sc1 lds
  s_waitcnt vmcnt(15)
  v_mfma_f32_32x32x16_bf16 v[64:79], a[88:91], v[180:183], v[64:79]
  buffer_load_dwordx4 v1, s[4:7], s46 offen offset:1024 sc1 lds
  v_mfma_f32_32x32x16_bf16 v[80:95], a[92:95], v[180:183], v[80:95]
  buffer_load_dwordx4 v1, s[4:7], s46 offen offset:2048 sc1 lds
  s_waitcnt vmcnt(16)
  v_mfma_f32_32x32x16_bf16 v[64:79], a[144:147], v[184:187], v[64:79]
  v_mfma_f32_32x32x16_bf16 v[80:95], a[148:151], v[184:187], v[80:95]
  buffer_load_dwordx4 v1, s[4:7], s46 offen offset:3072 sc1 lds
  s_waitcnt vmcnt(16)
  v_mfma_f32_32x32x16_bf16 v[64:79], a[200:203], v[188:191], v[64:79]
  s_add_u32 s46, s26, 32768
  s_add_u32 m0, s22, 32768
  s_nop 0
  buffer_load_dwordx4 v1, s[4:7], s46 offen offset:0 sc1 lds
  v_mfma_f32_32x32x16_bf16 v[80:95], a[204:207], v[188:191], v[80:95]
  s_waitcnt vmcnt(16)
  v_mfma_f32_32x32x16_bf16 v[64:79], a[40:43], v[192:195], v[64:79]
  buffer_load_dwordx4 v1, s[4:7], s46 offen offset:1024 sc1 lds
  v_mfma_f32_32x32x16_bf16 v[80:95], a[44:47], v[192:195], v[80:95]
  buffer_load_dwordx4 v1, s[4:7], s46 offen offset:2048 sc1 lds
  s_waitcnt vmcnt(17)
  v_mfma_f32_32x32x16_bf16 v[64:79], a[96:99], v[196:199], v[64:79]
  v_mfma_f32_32x32x16_bf16 v[80:95], a[100:103], v[196:199], v[80:95]
  buffer_load_dwordx4 v1, s[4:7], s46 offen offset:3072 sc1 lds
  s_waitcnt vmcnt(17)
  v_mfma_f32_32x32x16_bf16 v[64:79], a[152:155], v[200:203], v[64:79]
  s_add_u32 s46, s26, 36864
  s_add_u32 m0, s22, 36864
  s_nop 0
  buffer_load_dwordx4 v1, s[4:7], s46 offen offset:0 sc1 lds
  v_mfma_f32_32x32x16_bf16 v[80:95], a[156:159], v[200:203], v[80:95]
  buffer_load_dwordx4 v1, s[4:7], s46 offen offset:1024 sc1 lds
  s_waitcnt vmcnt(18)
  v_mfma_f32_32x32x16_bf16 v[64:79], a[208:211], v[204:207], v[64:79]
  v_mfma_f32_32x32x16_bf16 v[80:95], a[212:215], v[204:207], v[80:95]
  buffer_load_dwordx4 v1, s[4:7], s46 offen offset:2048 sc1 lds
  s_waitcnt vmcnt(18)
  v_mfma_f32_32x32x16_bf16 v[64:79], a[48:51], v[208:211], v[64:79]
  buffer_load_dwordx4 v1, s[4:7], s46 offen offset:3072 sc1 lds
  s_waitcnt vmcnt(18)
  v_mfma_f32_32x32x16_bf16 v[64:79], a[104:107], v[212:215], v[64:79]
  s_waitcnt vmcnt(17)
  v_mfma_f32_32x32x16_bf16 v[64:79], a[160:163], v[216:219], v[64:79]
  s_waitcnt vmcnt(16)
  v_mfma_f32_32x32x16_bf16 v[64:79], a[216:219], v[220:223], v[64:79]
  v_mfma_f32_32x32x16_bf16 v[80:95], a[52:55], v[208:211], v[80:95]
  v_mfma_f32_32x32x16_bf16 v[80:95], a[108:111], v[212:215], v[80:95]
  s_add_u32 s44, s22, 98304
  v_add_u32_e64 v30, s44, v1
  v_xor_b32 v31, 0x80, v30
  s_nop 6
  ds_write_b128 v30, v[64:67] offset:0
  ds_write_b128 v30, v[68:71] offset:1024
  v_mfma_f32_32x32x16_bf16 v[80:95], a[164:167], v[216:219], v[80:95]
  ds_write_b128 v30, v[72:75] offset:2048
  ds_write_b128 v30, v[76:79] offset:3072
  v_mfma_f32_32x32x16_bf16 v[80:95], a[220:223], v[220:223], v[80:95]
  s_nop 11
  ds_write_b128 v31, v[80:83] offset:4096
  ds_write_b128 v31, v[84:87] offset:5120
  ds_write_b128 v31, v[88:91] offset:6144
  ds_write_b128 v31, v[92:95] offset:7168
  v_accvgpr_read_b32 v16, a224
  v_accvgpr_read_b32 v17, a225
  v_accvgpr_read_b32 v18, a226
  v_accvgpr_read_b32 v19, a227
  v_accvgpr_read_b32 v20, a228
  v_accvgpr_read_b32 v21, a229
  v_accvgpr_read_b32 v22, a230
  v_accvgpr_read_b32 v23, a231
  v_accvgpr_read_b32 v24, a232
  v_accvgpr_read_b32 v25, a233
  v_accvgpr_read_b32 v26, a234
  v_accvgpr_read_b32 v27, a235
  v_accvgpr_read_b32 v28, a236
  v_accvgpr_read_b32 v29, a237
  v_accvgpr_read_b32 v30, a238
  v_accvgpr_read_b32 v31, a239
  s_waitcnt lgkmcnt(0)
  s_barrier
  ds_read_b128 v[128:131], v4 offset:0
  ds_read_b128 v[132:135], v4 offset:1024
  ds_read_b128 v[136:139], v4 offset:8192
  ds_read_b128 v[140:143], v4 offset:9216
  ds_read_b128 v[144:147], v4 offset:16384
  ds_read_b128 v[148:151], v4 offset:17408
  ds_read_b128 v[152:155], v4 offset:24576
  ds_read_b128 v[156:159], v4 offset:25600
  ds_read_b128 v[160:163], v4 offset:32768
  ds_read_b128 v[164:167], v4 offset:33792
  ds_read_b128 v[168:171], v4 offset:40960
  ds_read_b128 v[172:175], v4 offset:41984
  ds_read_b128 v[176:179], v4 offset:49152
  ds_read_b128 v[180:183], v4 offset:50176
  ds_read_b128 v[184:187], v4 offset:57344
  ds_read_b128 v[188:191], v4 offset:58368
  s_waitcnt lgkmcnt(14)
  v_pk_add_f32 v[16:17], v[16:17], v[128:129]
  v_pk_add_f32 v[18:19], v[18:19], v[130:131]
  v_pk_add_f32 v[20:21], v[20:21], v[132:133]
  v_pk_add_f32 v[22:23], v[22:23], v[134:135]
  s_waitcnt lgkmcnt(12)
  v_pk_add_f32 v[16:17], v[16:17], v[136:137]
  v_pk_add_f32 v[18:19], v[18:19], v[138:139]
  v_pk_add_f32 v[20:21], v[20:21], v[140:141]
  v_pk_add_f32 v[22:23], v[22:23], v[142:143]
  s_waitcnt lgkmcnt(10)
  v_pk_add_f32 v[16:17], v[16:17], v[144:145]
  v_pk_add_f32 v[18:19], v[18:19], v[146:147]
  v_pk_add_f32 v[20:21], v[20:21], v[148:149]
  v_pk_add_f32 v[22:23], v[22:23], v[150:151]
  s_waitcnt lgkmcnt(8)
  v_pk_add_f32 v[16:17], v[16:17], v[152:153]
  v_pk_add_f32 v[18:19], v[18:19], v[154:155]
  v_pk_add_f32 v[20:21], v[20:21], v[156:157]
  v_pk_add_f32 v[22:23], v[22:23], v[158:159]
  v_cvt_pk_bf16_f32 v136, v16, v17
  v_cvt_pk_bf16_f32 v137, v18, v19
  v_cvt_pk_bf16_f32 v138, v20, v21
  v_cvt_pk_bf16_f32 v139, v22, v23
  s_add_u32 s44, s41, 14680064
  buffer_store_dwordx4 v[136:139], v5, s[4:7], s44 offen sc0 sc1
  v_mov_b32 v140, v136
  v_mov_b32 v141, v137
  v_mov_b32 v142, v138
  v_mov_b32 v143, v139
  s_nop 0
  v_permlane32_swap_b32 v140, v142
  v_permlane32_swap_b32 v141, v143
  s_add_u32 s44, s43, 0
  buffer_store_dwordx4 v[140:143], v7, s[8:11], s44 offen
  s_waitcnt lgkmcnt(6)
  v_pk_add_f32 v[24:25], v[24:25], v[160:161]
  v_pk_add_f32 v[26:27], v[26:27], v[162:163]
  v_pk_add_f32 v[28:29], v[28:29], v[164:165]
  v_pk_add_f32 v[30:31], v[30:31], v[166:167]
  s_waitcnt lgkmcnt(4)
  v_pk_add_f32 v[24:25], v[24:25], v[168:169]
  v_pk_add_f32 v[26:27], v[26:27], v[170:171]
  v_pk_add_f32 v[28:29], v[28:29], v[172:173]
  v_pk_add_f32 v[30:31], v[30:31], v[174:175]
  s_waitcnt lgkmcnt(2)
  v_pk_add_f32 v[24:25], v[24:25], v[176:177]
  v_pk_add_f32 v[26:27], v[26:27], v[178:179]
  v_pk_add_f32 v[28:29], v[28:29], v[180:181]
  v_pk_add_f32 v[30:31], v[30:31], v[182:183]
  s_waitcnt lgkmcnt(0)
  v_pk_add_f32 v[24:25], v[24:25], v[184:185]
  v_pk_add_f32 v[26:27], v[26:27], v[186:187]
  v_pk_add_f32 v[28:29], v[28:29], v[188:189]
  v_pk_add_f32 v[30:31], v[30:31], v[190:191]
  v_cvt_pk_bf16_f32 v168, v24, v25
  v_cvt_pk_bf16_f32 v169, v26, v27
  v_cvt_pk_bf16_f32 v170, v28, v29
  v_cvt_pk_bf16_f32 v171, v30, v31
  s_add_u32 s44, s41, 14712832
  buffer_store_dwordx4 v[168:171], v5, s[4:7], s44 offen sc0 sc1
  v_mov_b32 v172, v168
  v_mov_b32 v173, v169
  v_mov_b32 v174, v170
  v_mov_b32_e64 v175, v171
  s_nop 0
  v_permlane32_swap_b32 v172, v174
  v_permlane32_swap_b32 v173, v175
  s_add_u32 s44, s43, 32768
  buffer_store_dwordx4 v[172:175], v7, s[8:11], s44 offen
  s_cbranch_vccz M_done
  v_pk_add_f32 v[128:129], v[16:17], v[18:19]
  v_pk_add_f32 v[160:161], v[24:25], v[26:27]
  v_pk_mul_f32 v[130:131], v[16:17], v[16:17]
  v_pk_mul_f32 v[162:163], v[24:25], v[24:25]
  v_pk_add_f32 v[132:133], v[20:21], v[22:23]
  v_pk_add_f32 v[164:165], v[28:29], v[30:31]
  v_pk_fma_f32 v[130:131], v[18:19], v[18:19], v[130:131]
  v_pk_fma_f32 v[162:163], v[26:27], v[26:27], v[162:163]
  v_pk_add_f32 v[128:129], v[128:129], v[132:133]
  v_pk_add_f32 v[160:161], v[160:161], v[164:165]
  v_pk_fma_f32 v[130:131], v[20:21], v[20:21], v[130:131]
  v_pk_fma_f32 v[162:163], v[28:29], v[28:29], v[162:163]
  v_pk_fma_f32 v[130:131], v[22:23], v[22:23], v[130:131]
  v_pk_fma_f32 v[162:163], v[30:31], v[30:31], v[162:163]
  v_add_f32 v128, v128, v129
  v_add_f32 v160, v160, v161
  v_add_f32 v129, v130, v131
  v_add_f32_e64 v161, v162, v163
  v_add_f32_dpp v128, v128, v128 row_ror:8 row_mask:0xf bank_mask:0xf
  v_add_f32_dpp v160, v160, v160 row_ror:8 row_mask:0xf bank_mask:0xf
  v_add_f32_dpp v129, v129, v129 row_ror:8 row_mask:0xf bank_mask:0xf
  v_add_f32_dpp v161, v161, v161 row_ror:8 row_mask:0xf bank_mask:0xf
  v_mov_b32 v130, v128
  v_mov_b32 v162, v160
  v_mov_b32 v131, v129
  v_mov_b32 v163, v161
  v_permlane16_swap_b32 v128, v130
  v_permlane16_swap_b32 v160, v162
  v_permlane16_swap_b32 v129, v131
  v_permlane16_swap_b32 v161, v163
  v_pk_add_f32 v[128:129], v[128:129], v[130:131]
  v_pk_add_f32 v[160:161], v[160:161], v[162:163]
  v_mov_b32 v130, v128
  v_mov_b32 v162, v160
  v_mov_b32 v131, v129
  v_mov_b32 v163, v161
  v_permlane32_swap_b32 v128, v130
  v_permlane32_swap_b32 v160, v162
  v_permlane32_swap_b32 v129, v131
  v_permlane32_swap_b32 v161, v163
  v_pk_add_f32 v[128:129], v[128:129], v[130:131]
  v_pk_add_f32 v[160:161], v[160:161], v[162:163]
  s_add_u32 s44, s38, 16777216
  s_mov_b64 exec, 0xff
  buffer_store_dwordx2 v[128:129], v6, s[4:7], s44 offen sc0 sc1
  buffer_store_dwordx2 v[160:161], v6, s[4:7], s44 offen offset:2048 sc0 sc1
  s_mov_b64 exec, -1
  v_accvgpr_write_b32 a224, v16
  v_accvgpr_write_b32 a225, v17
  v_accvgpr_write_b32 a226, v18
  v_accvgpr_write_b32 a227, v19
  v_accvgpr_write_b32 a228, v20
  v_accvgpr_write_b32 a229, v21
  v_accvgpr_write_b32 a230, v22
  v_accvgpr_write_b32 a231, v23
  v_accvgpr_write_b32 a232, v24
  v_accvgpr_write_b32 a233, v25
  v_accvgpr_write_b32 a234, v26
  v_accvgpr_write_b32 a235, v27
  v_accvgpr_write_b32 a236, v28
  v_accvgpr_write_b32 a237, v29
  v_accvgpr_write_b32 a238, v30
  v_accvgpr_write_b32 a239, v31
  s_add_u32 s15, s15, 1
  s_add_u32 s16, s16, 14680064
  s_add_u32 s44, s16, 2396160
  s_add_u32 s12, s4, s44
  s_addc_u32 s13, s5, 0
  s_add_u32 s58, s12, 14680064
  s_addc_u32 s59, s13, 0
  s_lshl_b32 s44, s21, 15
  s_add_u32 s34, s16, s44
  s_lshl_b32 s44, s21, 11
  s_add_u32 s35, s16, s44
  s_lshl_b32 s44, s19, 16
  s_add_u32 s36, s16, s44
  s_lshl_b32 s44, s20, 12
  s_add_u32 s37, s36, s44
  s_lshl_b32 s45, s14, 7
  s_add_u32 s37, s37, s45
  s_lshl_b32 s44, s19, 12
  s_add_u32 s38, s16, s44
  s_lshl_b32 s45, s14, 6
  s_add_u32 s38, s38, s45
  s_lshl_b32 s44, s20, 8
  s_add_u32 s38, s38, s44
  s_cmp_eq_u32 s15, 0
  s_cselect_b64 vcc, -1, 0
  s_waitcnt vmcnt(0)
  s_barrier
  s_cmp_ge_u32 s14, 2
  s_cbranch_scc1 L48
  s_lshl_b32 s44, s19, 1
  s_add_u32 s44, s44, s14
  s_lshl_b32 s44, s44, 7
  s_add_u32 s44, s44, 0
  s_mov_b32 s52, 1
  s_atomic_add s52, s[12:13], s44
L48:
  s_add_u32 s46, s25, 65536
  s_add_u32 m0, s22, 98304
  s_nop 0
  buffer_load_dwordx4 v1, s[4:7], s46 offen offset:0 sc1 lds
  buffer_load_dwordx4 v1, s[4:7], s46 offen offset:1024 sc1 lds
  buffer_load_dwordx4 v1, s[4:7], s46 offen offset:2048 sc1 lds
  buffer_load_dwordx4 v1, s[4:7], s46 offen offset:3072 sc1 lds
  s_add_u32 s46, s25, 69632
  s_add_u32 m0, s22, 102400
  s_nop 0
  buffer_load_dwordx4 v1, s[4:7], s46 offen offset:0 sc1 lds
  buffer_load_dwordx4 v1, s[4:7], s46 offen offset:1024 sc1 lds
  buffer_load_dwordx4 v1, s[4:7], s46 offen offset:2048 sc1 lds
  buffer_load_dwordx4 v1, s[4:7], s46 offen offset:3072 sc1 lds
  s_lshl_b32 s44, s21, 7
  s_add_u32 s44, s44, 0
  s_mov_b32 s50, 0
PL49:
  s_mov_b32 s51, 0
  s_atomic_add s51, s[12:13], s44 glc
  s_waitcnt lgkmcnt(0)
  s_cmp_ge_u32 s51, 8
  s_cbranch_scc1 PD50
  s_add_u32 s50, s50, 1
  s_cmp_lt_u32 s50, 20000
  s_cbranch_scc1 PL49
PD50:
  buffer_load_dwordx4 v[128:131], v1, s[4:7], s34 offen offset:0 sc1
  buffer_load_dwordx4 v[132:135], v1, s[4:7], s34 offen offset:1024 sc1
  buffer_load_dwordx4 v[136:139], v1, s[4:7], s34 offen offset:2048 sc1
  buffer_load_dwordx4 v[140:143], v1, s[4:7], s34 offen offset:3072 sc1
  s_add_u32 s48, s34, 4096
  buffer_load_dwordx4 v[144:147], v1, s[4:7], s48 offen offset:0 sc1
  buffer_load_dwordx4 v[148:151], v1, s[4:7], s48 offen offset:1024 sc1
  buffer_load_dwordx4 v[152:155], v1, s[4:7], s48 offen offset:2048 sc1
  buffer_load_dwordx4 v[156:159], v1, s[4:7], s48 offen offset:3072 sc1
  s_add_u32 s49, s35, 2097152
  buffer_load_dwordx2 v[16:17], v6, s[4:7], s49 offen offset:0 sc1
  buffer_load_dwordx2 v[18:19], v6, s[4:7], s49 offen offset:512 sc1
  buffer_load_dwordx2 v[20:21], v6, s[4:7], s49 offen offset:1024 sc1
  buffer_load_dwordx2 v[22:23], v6, s[4:7], s49 offen offset:1536 sc1
  s_add_u32 s48, s34, 8192
  buffer_load_dwordx4 v[160:163], v1, s[4:7], s48 offen offset:0 sc1
  buffer_load_dwordx4 v[164:167], v1, s[4:7], s48 offen offset:1024 sc1
  buffer_load_dwordx4 v[168:171], v1, s[4:7], s48 offen offset:2048 sc1
  buffer_load_dwordx4 v[172:175], v1, s[4:7], s48 offen offset:3072 sc1
  ds_read_b128 v[32:35], v1 offset:0
  ds_read_b128 v[36:39], v1 offset:1024
  ds_read_b128 v[40:43], v1 offset:2048
  ds_read_b128 v[44:47], v1 offset:3072
  ds_read_b128 v[48:51], v1 offset:4096
  ds_read_b128 v[52:55], v1 offset:5120
  s_waitcnt vmcnt(15) lgkmcnt(5)
  v_mfma_f32_32x32x16_bf16 v[64:79], v[128:131], v[32:35], 0
  ds_read_b128 v[56:59], v1 offset:6144
  s_waitcnt lgkmcnt(5)
  v_mfma_f32_32x32x16_bf16 v[80:95], v[128:131], v[36:39], 0
  ds_read_b128 v[60:63], v1 offset:7168
  s_add_u32 s48, s34, 12288
  buffer_load_dwordx4 v[176:179], v1, s[4:7], s48 offen offset:0 sc1
  s_waitcnt vmcnt(15) lgkmcnt(5)
  v_mfma_f32_32x32x16_bf16 v[64:79], v[132:135], v[40:43], v[64:79]
  ds_read_b128 v[32:35], v1 offset:8192
  s_waitcnt lgkmcnt(5)
  v_mfma_f32_32x32x16_bf16 v[80:95], v[132:135], v[44:47], v[80:95]
  ds_read_b128 v[36:39], v1 offset:9216
  buffer_load_dwordx4 v[180:183], v1, s[4:7], s48 offen offset:1024 sc1
  s_waitcnt vmcnt(15) lgkmcnt(5)
  v_mfma_f32_32x32x16_bf16 v[64:79], v[136:139], v[48:51], v[64:79]
  ds_read_b128 v[40:43], v1 offset:10240
  s_waitcnt lgkmcnt(5)
  v_mfma_f32_32x32x16_bf16 v[80:95], v[136:139], v[52:55], v[80:95]
  ds_read_b128 v[44:47], v1 offset:11264
  buffer_load_dwordx4 v[184:187], v1, s[4:7], s48 offen offset:2048 sc1
  s_waitcnt vmcnt(15) lgkmcnt(5)
  v_mfma_f32_32x32x16_bf16 v[64:79], v[140:143], v[56:59], v[64:79]
  ds_read_b128 v[48:51], v1 offset:12288
  s_waitcnt lgkmcnt(5)
  v_mfma_f32_32x32x16_bf16 v[80:95], v[140:143], v[60:63], v[80:95]
  ds_read_b128 v[52:55], v1 offset:13312
  buffer_load_dwordx4 v[188:191], v1, s[4:7], s48 offen offset:3072 sc1
  s_waitcnt vmcnt(15) lgkmcnt(5)
  v_mfma_f32_32x32x16_bf16 v[64:79], v[144:147], v[32:35], v[64:79]
  ds_read_b128 v[56:59], v1 offset:14336
  s_waitcnt lgkmcnt(5)
  v_mfma_f32_32x32x16_bf16 v[80:95], v[144:147], v[36:39], v[80:95]
  ds_read_b128 v[60:63], v1 offset:15360
  s_add_u32 s48, s34, 16384
  buffer_load_dwordx4 v[192:195], v1, s[4:7], s48 offen offset:0 sc1
  s_waitcnt vmcnt(15) lgkmcnt(5)
  v_mfma_f32_32x32x16_bf16 v[64:79], v[148:151], v[40:43], v[64:79]
  ds_read_b128 v[32:35], v1 offset:16384
  s_waitcnt lgkmcnt(5)
  v_mfma_f32_32x32x16_bf16 v[80:95], v[148:151], v[44:47], v[80:95]
  ds_read_b128 v[36:39], v1 offset:17408
  buffer_load_dwordx4 v[196:199], v1, s[4:7], s48 offen offset:1024 sc1
  s_waitcnt vmcnt(15) lgkmcnt(5)
  v_mfma_f32_32x32x16_bf16 v[64:79], v[152:155], v[48:51], v[64:79]
  ds_read_b128 v[40:43], v1 offset:18432
  s_waitcnt lgkmcnt(5)
  v_mfma_f32_32x32x16_bf16 v[80:95], v[152:155], v[52:55], v[80:95]
  ds_read_b128 v[44:47], v1 offset:19456
  buffer_load_dwordx4 v[200:203], v1, s[4:7], s48 offen offset:2048 sc1
  s_waitcnt vmcnt(15) lgkmcnt(5)
  v_mfma_f32_32x32x16_bf16 v[64:79], v[156:159], v[56:59], v[64:79]
  ds_read_b128 v[48:51], v1 offset:20480
  s_waitcnt lgkmcnt(5)
  v_mfma_f32_32x32x16_bf16 v[80:95], v[156:159], v[60:63], v[80:95]
  ds_read_b128 v[52:55], v1 offset:21504
  buffer_load_dwordx4 v[204:207], v1, s[4:7], s48 offen offset:3072 sc1
  s_waitcnt vmcnt(11) lgkmcnt(5)
  v_mfma_f32_32x32x16_bf16 v[64:79], v[160:163], v[32:35], v[64:79]
  ds_read_b128 v[56:59], v1 offset:22528
  s_waitcnt lgkmcnt(5)
  v_mfma_f32_32x32x16_bf16 v[80:95], v[160:163], v[36:39], v[80:95]
  ds_read_b128 v[60:63], v1 offset:23552
  s_add_u32 s48, s34, 20480
  buffer_load_dwordx4 v[208:211], v1, s[4:7], s48 offen offset:0 sc1
  v_add_f32_e64 v16, v16, v18
  s_waitcnt vmcnt(11) lgkmcnt(5)
  v_mfma_f32_32x32x16_bf16 v[64:79], v[164:167], v[40:43], v[64:79]
  ds_read_b128 v[32:35], v1 offset:24576
  v_add_f32 v17, v17, v19
  s_waitcnt lgkmcnt(5)
  v_mfma_f32_32x32x16_bf16 v[80:95], v[164:167], v[44:47], v[80:95]
  ds_read_b128 v[36:39], v1 offset:25600
  buffer_load_dwordx4 v[212:215], v1, s[4:7], s48 offen offset:1024 sc1
  v_add_f32 v20, v20, v22
  s_waitcnt vmcnt(11) lgkmcnt(5)
  v_mfma_f32_32x32x16_bf16 v[64:79], v[168:171], v[48:51], v[64:79]
  ds_read_b128 v[40:43], v1 offset:26624
  v_add_f32 v21, v21, v23
  s_waitcnt lgkmcnt(5)
  v_mfma_f32_32x32x16_bf16 v[80:95], v[168:171], v[52:55], v[80:95]
  ds_read_b128 v[44:47], v1 offset:27648
  buffer_load_dwordx4 v[216:219], v1, s[4:7], s48 offen offset:2048 sc1
  v_add_f32 v16, v16, v20
  s_waitcnt vmcnt(11) lgkmcnt(5)
  v_mfma_f32_32x32x16_bf16 v[64:79], v[172:175], v[56:59], v[64:79]
  ds_read_b128 v[48:51], v1 offset:28672
  v_add_f32 v17, v17, v21
  s_waitcnt lgkmcnt(5)
  v_mfma_f32_32x32x16_bf16 v[80:95], v[172:175], v[60:63], v[80:95]
  ds_read_b128 v[52:55], v1 offset:29696
  buffer_load_dwordx4 v[220:223], v1, s[4:7], s48 offen offset:3072 sc1
  v_mov_b32 v18, v16
  s_waitcnt vmcnt(11) lgkmcnt(5)
  v_mfma_f32_32x32x16_bf16 v[64:79], v[176:179], v[32:35], v[64:79]
  ds_read_b128 v[56:59], v1 offset:30720
  v_mov_b32 v19, v17
  s_waitcnt lgkmcnt(5)
  v_mfma_f32_32x32x16_bf16 v[80:95], v[176:179], v[36:39], v[80:95]
  ds_read_b128 v[60:63], v1 offset:31744
  s_add_u32 s48, s34, 24576
  buffer_load_dwordx4 v[224:227], v1, s[4:7], s48 offen offset:0 sc1
  v_permlane32_swap_b32 v16, v18
  s_waitcnt vmcnt(11) lgkmcnt(5)
  v_mfma_f32_32x32x16_bf16 v[64:79], v[180:183], v[40:43], v[64:79]
  ds_read_b128 v[32:35], v1 offset:32768
  v_permlane32_swap_b32 v17, v19
  s_waitcnt lgkmcnt(5)
  v_mfma_f32_32x32x16_bf16 v[80:95], v[180:183], v[44:47], v[80:95]
  ds_read_b128 v[36:39], v1 offset:33792
  buffer_load_dwordx4 v[228:231], v1, s[4:7], s48 offen offset:1024 sc1
  v_add_f32 v16, v16, v18
  s_waitcnt vmcnt(11) lgkmcnt(5)
  v_mfma_f32_32x32x16_bf16 v[64:79], v[184:187], v[48:51], v[64:79]
  ds_read_b128 v[40:43], v1 offset:34816
  v_add_f32 v17, v17, v19
  s_waitcnt lgkmcnt(5)
  v_mfma_f32_32x32x16_bf16 v[80:95], v[184:187], v[52:55], v[80:95]
  ds_read_b128 v[44:47], v1 offset:35840
  buffer_load_dwordx4 v[232:235], v1, s[4:7], s48 offen offset:2048 sc1
  v_mul_f32 v16, 0xbb000000, v16
  s_waitcnt vmcnt(11) lgkmcnt(5)
  v_mfma_f32_32x32x16_bf16 v[64:79], v[188:191], v[56:59], v[64:79]
  ds_read_b128 v[48:51], v1 offset:36864
  v_mul_f32 v17, 0x3b000000, v17
  s_waitcnt lgkmcnt(5)
  v_mfma_f32_32x32x16_bf16 v[80:95], v[188:191], v[60:63], v[80:95]
  ds_read_b128 v[52:55], v1 offset:37888
  buffer_load_dwordx4 v[236:239], v1, s[4:7], s48 offen offset:3072 sc1
  v_fma_f32 v17, -v16, v16, v17
  s_waitcnt vmcnt(11) lgkmcnt(5)
  v_mfma_f32_32x32x16_bf16 v[64:79], v[192:195], v[32:35], v[64:79]
  ds_read_b128 v[56:59], v1 offset:38912
  v_max_f32_e64 v17, 0, v17
  s_waitcnt lgkmcnt(5)
  v_mfma_f32_32x32x16_bf16 v[80:95], v[192:195], v[36:39], v[80:95]
  ds_read_b128 v[60:63], v1 offset:39936
  s_add_u32 s48, s34, 28672
  buffer_load_dwordx4 v[240:243], v1, s[4:7], s48 offen offset:0 sc1
  v_add_f32 v17, 0x3727c5ac, v17
  s_waitcnt vmcnt(11) lgkmcnt(5)
  v_mfma_f32_32x32x16_bf16 v[64:79], v[196:199], v[40:43], v[64:79]
  ds_read_b128 v[32:35], v1 offset:40960
  v_rsq_f32_e64 v11, v17
  s_waitcnt lgkmcnt(5)
  v_mfma_f32_32x32x16_bf16 v[80:95], v[196:199], v[44:47], v[80:95]
  ds_read_b128 v[36:39], v1 offset:41984
  buffer_load_dwordx4 v[244:247], v1, s[4:7], s48 offen offset:1024 sc1
  v_cvt_pk_bf16_f32 v13, v16, 0
  s_waitcnt vmcnt(11) lgkmcnt(5)
  v_mfma_f32_32x32x16_bf16 v[64:79], v[200:203], v[48:51], v[64:79]
  ds_read_b128 v[40:43], v1 offset:43008
  v_lshlrev_b32_e64 v18, 16, v13
  s_waitcnt lgkmcnt(5)
  v_mfma_f32_32x32x16_bf16 v[80:95], v[200:203], v[52:55], v[80:95]
  ds_read_b128 v[44:47], v1 offset:44032
  buffer_load_dwordx4 v[248:251], v1, s[4:7], s48 offen offset:2048 sc1
  v_sub_f32 v18, v16, v18
  s_waitcnt vmcnt(11) lgkmcnt(5)
  v_mfma_f32_32x32x16_bf16 v[64:79], v[204:207], v[56:59], v[64:79]
  ds_read_b128 v[48:51], v1 offset:45056
  v_cvt_pk_bf16_f32 v12, v16, v18
  s_waitcnt lgkmcnt(5)
  v_mfma_f32_32x32x16_bf16 v[80:95], v[204:207], v[60:63], v[80:95]
  ds_read_b128 v[52:55], v1 offset:46080
  buffer_load_dwordx4 v[252:255], v1, s[4:7], s48 offen offset:3072 sc1
  v_mov_b32_e64 v15, v13
  s_waitcnt vmcnt(11) lgkmcnt(5)
  v_mfma_f32_32x32x16_bf16 v[64:79], v[208:211], v[32:35], v[64:79]
  ds_read_b128 v[56:59], v1 offset:47104
  v_mov_b32 v14, v12
  s_waitcnt lgkmcnt(5)
  v_mfma_f32_32x32x16_bf16 v[80:95], v[208:211], v[36:39], v[80:95]
  ds_read_b128 v[60:63], v1 offset:48128
  v_accvgpr_read_b32 v18, a240
  s_waitcnt vmcnt(10) lgkmcnt(5)
  v_mfma_f32_32x32x16_bf16 v[64:79], v[212:215], v[40:43], v[64:79]
  ds_read_b128 v[32:35], v1 offset:49152
  ds_write_b32 v18, v11
  s_waitcnt lgkmcnt(6)
  v_mfma_f32_32x32x16_bf16 v[80:95], v[212:215], v[44:47], v[80:95]
  ds_read_b128 v[36:39], v1 offset:50176
  ds_read_b128 v[112:115], v9 offset:0
  s_waitcnt vmcnt(9) lgkmcnt(7)
  v_mfma_f32_32x32x16_bf16 v[64:79], v[216:219], v[48:51], v[64:79]
  ds_read_b128 v[40:43], v1 offset:51200
  ds_read_b128 v[116:119], v9 offset:32
  s_waitcnt lgkmcnt(8)
  v_mfma_f32_32x32x16_bf16 v[80:95], v[216:219], v[52:55], v[80:95]
  ds_read_b128 v[44:47], v1 offset:52224
  ds_read_b128 v[120:123], v9 offset:64
  s_waitcnt vmcnt(8) lgkmcnt(9)
  v_mfma_f32_32x32x16_bf16 v[64:79], v[220:223], v[56:59], v[64:79]
  ds_read_b128 v[48:51], v1 offset:53248
  ds_read_b128 v[124:127], v9 offset:96
  s_waitcnt lgkmcnt(10)
  v_mfma_f32_32x32x16_bf16 v[80:95], v[220:223], v[60:63], v[80:95]
  ds_read_b128 v[52:55], v1 offset:54272
  s_waitcnt vmcnt(7) lgkmcnt(10)
  v_mfma_f32_32x32x16_bf16 v[64:79], v[224:227], v[32:35], v[64:79]
  ds_read_b128 v[56:59], v1 offset:55296
  s_waitcnt lgkmcnt(9)
  v_mfma_f32_32x32x16_bf16 v[80:95], v[224:227], v[36:39], v[80:95]
  ds_read_b128 v[60:63], v1 offset:56320
  s_waitcnt vmcnt(6) lgkmcnt(8)
  v_mfma_f32_32x32x16_bf16 v[64:79], v[228:231], v[40:43], v[64:79]
  ds_read_b128 v[32:35], v1 offset:57344
  s_waitcnt lgkmcnt(7)
  v_mfma_f32_32x32x16_bf16 v[80:95], v[228:231], v[44:47], v[80:95]
  ds_read_b128 v[36:39], v1 offset:58368
  s_waitcnt vmcnt(5) lgkmcnt(6)
  v_mfma_f32_32x32x16_bf16 v[64:79], v[232:235], v[48:51], v[64:79]
  ds_read_b128 v[40:43], v1 offset:59392
  s_waitcnt lgkmcnt(5)
  v_mfma_f32_32x32x16_bf16 v[80:95], v[232:235], v[52:55], v[80:95]
  ds_read_b128 v[44:47], v1 offset:60416
  s_waitcnt vmcnt(4) lgkmcnt(5)
  v_mfma_f32_32x32x16_bf16 v[64:79], v[236:239], v[56:59], v[64:79]
  ds_read_b128 v[48:51], v1 offset:61440
  s_waitcnt lgkmcnt(5)
  v_mfma_f32_32x32x16_bf16 v[80:95], v[236:239], v[60:63], v[80:95]
  ds_read_b128 v[52:55], v1 offset:62464
  s_waitcnt vmcnt(3) lgkmcnt(5)
  v_mfma_f32_32x32x16_bf16 v[64:79], v[240:243], v[32:35], v[64:79]
  ds_read_b128 v[56:59], v1 offset:63488
  s_waitcnt lgkmcnt(5)
  v_mfma_f32_32x32x16_bf16 v[80:95], v[240:243], v[36:39], v[80:95]
  ds_read_b128 v[60:63], v1 offset:64512
  s_waitcnt vmcnt(2) lgkmcnt(5)
  v_mfma_f32_32x32x16_bf16 v[64:79], v[244:247], v[40:43], v[64:79]
  ds_read_b128 v[32:35], v3 offset:4096
  s_waitcnt lgkmcnt(5)
  v_mfma_f32_32x32x16_bf16 v[80:95], v[244:247], v[44:47], v[80:95]
  ds_read_b128 v[36:39], v3 offset:5120
  s_waitcnt vmcnt(1) lgkmcnt(5)
  v_mfma_f32_32x32x16_bf16 v[64:79], v[248:251], v[48:51], v[64:79]
  s_waitcnt lgkmcnt(4)
  v_mfma_f32_32x32x16_bf16 v[80:95], v[248:251], v[52:55], v[80:95]
  s_barrier
  s_waitcnt vmcnt(0) lgkmcnt(3)
  v_mfma_f32_32x32x16_bf16 v[64:79], v[252:255], v[56:59], v[64:79]
  ds_read_b128 v[40:43], v2 offset:32768
  ds_read_b128 v[44:47], v2 offset:33792
  ds_read_b128 v[48:51], v2 offset:34816
  s_waitcnt lgkmcnt(5)
  v_mfma_f32_32x32x16_bf16 v[80:95], v[252:255], v[60:63], v[80:95]
  ds_read_b128 v[52:55], v2 offset:35840
  s_waitcnt lgkmcnt(5)
  v_mfma_f32_32x32x16_bf16 v[64:79], v[12:15], v[32:35], v[64:79]
  ds_read_b128 v[56:59], v2 offset:36864
  s_waitcnt lgkmcnt(5)
  v_mfma_f32_32x32x16_bf16 v[80:95], v[12:15], v[36:39], v[80:95]
  ds_read_b128 v[60:63], v2 offset:37888
  s_waitcnt lgkmcnt(5)
  v_mfma_f32_32x32x16_bf16 v[96:111], v[40:43], v[128:131], 0
  ds_read_b128 v[32:35], v2 offset:38912
  s_nop 4
  v_pk_fma_f32 v[64:65], v[64:65], v[112:113], s[32:33] op_sel_hi:[1,1,0]
  v_pk_mul_f32 v[28:29], v[64:65], s[32:33] op_sel:[0,1] op_sel_hi:[1,1]
  v_exp_f32 v28, v28 clamp
  v_exp_f32 v29, v29 clamp
  v_max_f32 v64, s32, v64
  v_max_f32_e64 v65, s32, v65
  v_pk_add_f32 v[64:65], v[64:65], v[28:29]
  v_mov_b64 v[24:25], v[64:65]
  v_cvt_pk_bf16_f32 v16, v64, v65
  v_pk_fma_f32 v[66:67], v[66:67], v[114:115], s[32:33] op_sel_hi:[1,1,0]
  v_pk_mul_f32 v[30:31], v[66:67], s[32:33] op_sel:[0,1] op_sel_hi:[1,1]
  s_waitcnt lgkmcnt(5)
  v_mfma_f32_32x32x16_bf16 v[96:111], v[44:47], v[132:135], v[96:111]
  ds_read_b128 v[36:39], v2 offset:39936
  v_exp_f32 v30, v30 clamp
  v_exp_f32 v31, v31 clamp
  v_max_f32 v66, s32, v66
  v_max_f32 v67, s32, v67
  v_pk_add_f32 v[66:67], v[66:67], v[30:31]
  v_pk_add_f32 v[24:25], v[24:25], v[66:67]
  v_cvt_pk_bf16_f32 v17, v66, v67
  v_pk_fma_f32 v[68:69], v[68:69], v[116:117], s[32:33] op_sel_hi:[1,1,0]
  v_pk_mul_f32 v[28:29], v[68:69], s[32:33] op_sel:[0,1] op_sel_hi:[1,1]
  v_exp_f32 v28, v28 clamp
  v_exp_f32 v29, v29 clamp
  v_max_f32 v68, s32, v68
  s_waitcnt lgkmcnt(5)
  v_mfma_f32_32x32x16_bf16 v[96:111], v[48:51], v[136:139], v[96:111]
  ds_read_b128 v[40:43], v2 offset:40960
  v_max_f32_e64 v69, s32, v69
  v_pk_add_f32 v[68:69], v[68:69], v[28:29]
  v_pk_add_f32 v[24:25], v[24:25], v[68:69]
  v_cvt_pk_bf16_f32 v18, v68, v69
  v_pk_fma_f32 v[70:71], v[70:71], v[118:119], s[32:33] op_sel_hi:[1,1,0]
  v_pk_mul_f32 v[30:31], v[70:71], s[32:33] op_sel:[0,1] op_sel_hi:[1,1]
  v_exp_f32 v30, v30 clamp
  v_exp_f32 v31, v31 clamp
  v_max_f32 v70, s32, v70
  v_max_f32 v71, s32, v71
  v_pk_add_f32 v[70:71], v[70:71], v[30:31]
  v_pk_add_f32 v[24:25], v[24:25], v[70:71]
  s_waitcnt lgkmcnt(5)
  v_mfma_f32_32x32x16_bf16 v[96:111], v[52:55], v[140:143], v[96:111]
  ds_read_b128 v[44:47], v2 offset:41984
  v_cvt_pk_bf16_f32 v19, v70, v71
  v_pk_fma_f32 v[72:73], v[72:73], v[120:121], s[32:33] op_sel_hi:[1,1,0]
  v_pk_mul_f32 v[28:29], v[72:73], s[32:33] op_sel:[0,1] op_sel_hi:[1,1]
  v_exp_f32 v28, v28 clamp
  v_exp_f32 v29, v29 clamp
  v_max_f32 v72, s32, v72
  v_max_f32_e64 v73, s32, v73
  v_pk_add_f32 v[72:73], v[72:73], v[28:29]
  v_pk_add_f32 v[24:25], v[24:25], v[72:73]
  v_cvt_pk_bf16_f32 v20, v72, v73
  v_pk_fma_f32 v[74:75], v[74:75], v[122:123], s[32:33] op_sel_hi:[1,1,0]
  v_pk_mul_f32 v[30:31], v[74:75], s[32:33] op_sel:[0,1] op_sel_hi:[1,1]
  s_waitcnt lgkmcnt(5)
  v_mfma_f32_32x32x16_bf16 v[96:111], v[56:59], v[144:147], v[96:111]
  ds_read_b128 v[48:51], v2 offset:43008
  v_exp_f32 v30, v30 clamp
  v_exp_f32 v31, v31 clamp
  v_max_f32 v74, s32, v74
  v_max_f32_e64 v75, s32, v75
  v_pk_add_f32 v[74:75], v[74:75], v[30:31]
  v_pk_add_f32 v[24:25], v[24:25], v[74:75]
  v_cvt_pk_bf16_f32 v21, v74, v75
  v_pk_fma_f32 v[76:77], v[76:77], v[124:125], s[32:33] op_sel_hi:[1,1,0]
  v_pk_mul_f32 v[28:29], v[76:77], s[32:33] op_sel:[0,1] op_sel_hi:[1,1]
  v_exp_f32 v28, v28 clamp
  v_exp_f32 v29, v29 clamp
  v_max_f32 v76, s32, v76
  s_waitcnt lgkmcnt(5)
  v_mfma_f32_32x32x16_bf16 v[96:111], v[60:63], v[148:151], v[96:111]
  ds_read_b128 v[52:55], v2 offset:44032
  v_max_f32_e64 v77, s32, v77
  v_pk_add_f32 v[76:77], v[76:77], v[28:29]
  v_pk_add_f32 v[24:25], v[24:25], v[76:77]
  v_cvt_pk_bf16_f32 v22, v76, v77
  v_pk_fma_f32 v[78:79], v[78:79], v[126:127], s[32:33] op_sel_hi:[1,1,0]
  v_pk_mul_f32 v[30:31], v[78:79], s[32:33] op_sel:[0,1] op_sel_hi:[1,1]
  v_exp_f32 v30, v30 clamp
  v_exp_f32 v31, v31 clamp
  v_max_f32 v78, s32, v78
  v_max_f32 v79, s32, v79
  v_pk_add_f32 v[78:79], v[78:79], v[30:31]
  v_pk_add_f32 v[24:25], v[24:25], v[78:79]
  s_waitcnt lgkmcnt(5)
  v_mfma_f32_32x32x16_bf16 v[96:111], v[32:35], v[152:155], v[96:111]
  ds_read_b128 v[56:59], v2 offset:45056
  v_cvt_pk_bf16_f32 v23, v78, v79
  v_pk_mul_f32 v[80:81], v[80:81], v[112:113]
  v_cvt_pk_bf16_f32 v112, v80, v81
  v_pk_mul_f32 v[82:83], v[82:83], v[114:115]
  v_cvt_pk_bf16_f32 v113, v82, v83
  v_pk_mul_f32 v[84:85], v[84:85], v[116:117]
  v_cvt_pk_bf16_f32 v114, v84, v85
  v_pk_mul_f32 v[86:87], v[86:87], v[118:119]
  v_cvt_pk_bf16_f32 v115, v86, v87
  v_pk_mul_f32 v[88:89], v[88:89], v[120:121]
  v_cvt_pk_bf16_f32 v116, v88, v89
  v_pk_mul_f32 v[90:91], v[90:91], v[122:123]
  s_waitcnt lgkmcnt(5)
  v_mfma_f32_32x32x16_bf16 v[96:111], v[36:39], v[156:159], v[96:111]
  ds_read_b128 v[60:63], v2 offset:46080
  v_cvt_pk_bf16_f32 v117, v90, v91
  v_pk_mul_f32 v[92:93], v[92:93], v[124:125]
  v_cvt_pk_bf16_f32 v118, v92, v93
  v_pk_mul_f32 v[94:95], v[94:95], v[126:127]
  v_cvt_pk_bf16_f32 v119, v94, v95
  v_add_f32_e64 v10, v24, v25
  v_mfma_f32_32x32x16_bf16 v[64:79], v[16:19], v[112:115], 0
  v_mfma_f32_32x32x16_bf16 v[64:79], v[20:23], v[116:119], v[64:79]
  v_mov_b32_e64 v24, v10
  v_accvgpr_read_b32 v25, a241
  v_accvgpr_read_b32 v26, a244
  v_permlane32_swap_b32 v24, v10
  s_waitcnt lgkmcnt(5)
  v_mfma_f32_32x32x16_bf16 v[96:111], v[40:43], v[160:163], v[96:111]
  ds_read_b128 v[32:35], v2 offset:47104
  v_add_f32_e64 v24, v24, v10
  s_mul_i32 s49, s18, 2176
  s_add_u32 s49, s49, s16
  s_add_u32 s49, s49, 2359296
  ds_write_b32 v26, v24
  s_mov_b32 exec_lo, 0x0000ffff
  s_mov_b32 exec_hi, 0x0000ffff
  ds_write_b128 v25, v[64:67]
  ds_write_b128 v25, v[68:71] offset:16
  s_mov_b32 exec_lo, 0xffff0000
  s_mov_b32 exec_hi, 0xffff0000
  ds_write_b128 v25, v[72:75]
  ds_write_b128 v25, v[76:79] offset:16
  s_mov_b64 exec, -1
  v_accvgpr_read_b32 v25, a242
  v_accvgpr_read_b32 v27, a243
  s_waitcnt lgkmcnt(0)
  s_barrier
  ds_read2st64_b32 v[16:17], v25 offset0:0 offset1:1
  ds_read2st64_b32 v[18:19], v25 offset0:9 offset1:10
  ds_read2st64_b32 v[20:21], v25 offset0:18 offset1:19
  ds_read2st64_b32 v[22:23], v25 offset0:27 offset1:28
  ds_read_b32 v80, v25 offset:512
  ds_read_b32 v81, v25 offset:2816
  ds_read_b32 v82, v25 offset:5120
  ds_read_b32 v83, v25 offset:7424
  s_waitcnt lgkmcnt(4)
  v_pk_add_f32 v[16:17], v[16:17], v[18:19]
  v_pk_add_f32 v[20:21], v[20:21], v[22:23]
  v_mfma_f32_32x32x16_bf16 v[96:111], v[44:47], v[164:167], v[96:111]
  ds_read_b128 v[36:39], v2 offset:48128
  v_pk_add_f32 v[16:17], v[16:17], v[20:21]
  buffer_atomic_add_f32 v16, v27, s[4:7], s49 offen
  buffer_atomic_add_f32 v17, v27, s[4:7], s49 offen offset:256
  s_waitcnt lgkmcnt(1)
  v_pk_add_f32 v[80:81], v[80:81], v[82:83]
  v_add_f32_e64 v80, v80, v81
  s_mov_b64 exec, 0xff
  buffer_atomic_add_f32 v80, v27, s[4:7], s49 offen offset:512
  s_mov_b64 exec, -1
  v_mfma_f32_32x32x16_bf16 v[96:111], v[48:51], v[168:171], v[96:111]
  ds_read_b128 v[40:43], v2 offset:49152
  v_mfma_f32_32x32x16_bf16 v[96:111], v[52:55], v[172:175], v[96:111]
  ds_read_b128 v[44:47], v2 offset:50176
  v_mfma_f32_32x32x16_bf16 v[96:111], v[56:59], v[176:179], v[96:111]
  ds_read_b128 v[48:51], v2 offset:51200
  v_mfma_f32_32x32x16_bf16 v[96:111], v[60:63], v[180:183], v[96:111]
  ds_read_b128 v[52:55], v2 offset:52224
  v_mfma_f32_32x32x16_bf16 v[96:111], v[32:35], v[184:187], v[96:111]
  ds_read_b128 v[56:59], v2 offset:53248
  s_waitcnt lgkmcnt(5)
  v_mfma_f32_32x32x16_bf16 v[96:111], v[36:39], v[188:191], v[96:111]
  ds_read_b128 v[60:63], v2 offset:54272
  s_waitcnt lgkmcnt(5)
  v_mfma_f32_32x32x16_bf16 v[96:111], v[40:43], v[192:195], v[96:111]
  ds_read_b128 v[32:35], v2 offset:55296
  s_waitcnt lgkmcnt(5)
  v_mfma_f32_32x32x16_bf16 v[96:111], v[44:47], v[196:199], v[96:111]
  ds_read_b128 v[36:39], v2 offset:56320
  s_waitcnt lgkmcnt(5)
  v_mfma_f32_32x32x16_bf16 v[96:111], v[48:51], v[200:203], v[96:111]
  ds_read_b128 v[40:43], v2 offset:57344
  s_waitcnt lgkmcnt(5)
  v_mfma_f32_32x32x16_bf16 v[96:111], v[52:55], v[204:207], v[96:111]
  ds_read_b128 v[44:47], v2 offset:58368
  s_waitcnt lgkmcnt(5)
  v_mfma_f32_32x32x16_bf16 v[96:111], v[56:59], v[208:211], v[96:111]
  ds_read_b128 v[48:51], v2 offset:59392
  s_waitcnt lgkmcnt(5)
  v_mfma_f32_32x32x16_bf16 v[96:111], v[60:63], v[212:215], v[96:111]
  ds_read_b128 v[52:55], v2 offset:60416
  s_waitcnt lgkmcnt(5)
  v_mfma_f32_32x32x16_bf16 v[96:111], v[32:35], v[216:219], v[96:111]
  ds_read_b128 v[56:59], v2 offset:61440
  s_waitcnt lgkmcnt(5)
  v_mfma_f32_32x32x16_bf16 v[96:111], v[36:39], v[220:223], v[96:111]
  ds_read_b128 v[60:63], v2 offset:62464
  s_waitcnt lgkmcnt(5)
  v_mfma_f32_32x32x16_bf16 v[96:111], v[40:43], v[224:227], v[96:111]
  ds_read_b128 v[32:35], v2 offset:63488
  s_waitcnt lgkmcnt(5)
  v_mfma_f32_32x32x16_bf16 v[96:111], v[44:47], v[228:231], v[96:111]
  ds_read_b128 v[36:39], v2 offset:64512
  s_add_u32 m0, s22, 65536
  s_nop 0
  buffer_load_dwordx4 v1, s[4:7], s28 offen offset:0 sc1 lds
  s_waitcnt lgkmcnt(5)
  v_mfma_f32_32x32x16_bf16 v[96:111], v[48:51], v[232:235], v[96:111]
  ds_read_b128 v[40:43], v3 offset:6144
  buffer_load_dwordx4 v1, s[4:7], s28 offen offset:1024 sc1 lds
  s_waitcnt lgkmcnt(5)
  v_mfma_f32_32x32x16_bf16 v[96:111], v[52:55], v[236:239], v[96:111]
  buffer_load_dwordx4 v1, s[4:7], s28 offen offset:2048 sc1 lds
  s_waitcnt lgkmcnt(4)
  v_mfma_f32_32x32x16_bf16 v[96:111], v[56:59], v[240:243], v[96:111]
  buffer_load_dwordx4 v1, s[4:7], s28 offen offset:3072 sc1 lds
  s_waitcnt lgkmcnt(3)
  v_mfma_f32_32x32x16_bf16 v[96:111], v[60:63], v[244:247], v[96:111]
  s_add_u32 s46, s28, 4096
  s_add_u32 m0, s22, 69632
  s_nop 0
  buffer_load_dwordx4 v1, s[4:7], s46 offen offset:0 sc1 lds
  s_waitcnt vmcnt(5)
  s_barrier
  s_cmp_lg_u32 s14, 3
  s_cbranch_scc1 L52
  v_lshlrev_b32 v28, 7, v0
  v_mov_b32_e64 v29, 1
  s_lshr_b32 s44, s18, 1
  s_lshl_b32 s44, s44, 11
  s_add_u32 s44, s44, s16
  s_add_u32 s44, s44, 2420736
  s_mov_b64 exec, 0xffff
  buffer_atomic_add v29, v28, s[4:7], s44 offen sc1
  s_mov_b64 exec, -1
L52:
  buffer_load_dwordx4 v1, s[4:7], s46 offen offset:1024 sc1 lds
  s_waitcnt lgkmcnt(2)
  v_mfma_f32_32x32x16_bf16 v[96:111], v[32:35], v[248:251], v[96:111]
  buffer_load_dwordx4 v1, s[4:7], s46 offen offset:2048 sc1 lds
  s_waitcnt lgkmcnt(1)
  v_mfma_f32_32x32x16_bf16 v[96:111], v[36:39], v[252:255], v[96:111]
  buffer_load_dwordx4 v1, s[4:7], s46 offen offset:3072 sc1 lds
  s_waitcnt lgkmcnt(0)
  v_mfma_f32_32x32x16_bf16 v[96:111], v[40:43], v[12:15], v[96:111]
  s_barrier
  s_lshl_b32 s44, s18, 11
  s_add_u32 s49, s34, s44
  v_mov_b32_e64 v24, v11
  s_nop 7
  v_pk_fma_f32 v[96:97], v[96:97], v[24:25], s[32:33] op_sel_hi:[1,0,0]
  v_pk_mul_f32 v[28:29], v[96:97], s[32:33] op_sel:[0,1] op_sel_hi:[1,1]
  v_exp_f32 v28, v28 clamp
  v_exp_f32 v29, v29 clamp
  v_max_f32 v96, s32, v96
  v_max_f32 v97, s32, v97
  v_pk_add_f32 v[96:97], v[96:97], v[28:29]
  v_cvt_pk_bf16_f32 v16, v96, v97
  v_pk_fma_f32 v[98:99], v[98:99], v[24:25], s[32:33] op_sel_hi:[1,0,0]
  v_pk_mul_f32 v[30:31], v[98:99], s[32:33] op_sel:[0,1] op_sel_hi:[1,1]
  v_exp_f32 v30, v30 clamp
  v_exp_f32 v31, v31 clamp
  v_max_f32 v98, s32, v98
  v_max_f32 v99, s32, v99
  v_pk_add_f32 v[98:99], v[98:99], v[30:31]
  v_cvt_pk_bf16_f32 v17, v98, v99
  v_pk_fma_f32 v[100:101], v[100:101], v[24:25], s[32:33] op_sel_hi:[1,0,0]
  v_pk_mul_f32 v[28:29], v[100:101], s[32:33] op_sel:[0,1] op_sel_hi:[1,1]
  v_exp_f32 v28, v28 clamp
  v_exp_f32 v29, v29 clamp
  v_max_f32 v100, s32, v100
  v_max_f32 v101, s32, v101
  v_pk_add_f32 v[100:101], v[100:101], v[28:29]
  v_cvt_pk_bf16_f32 v18, v100, v101
  v_pk_fma_f32 v[102:103], v[102:103], v[24:25], s[32:33] op_sel_hi:[1,0,0]
  v_pk_mul_f32 v[30:31], v[102:103], s[32:33] op_sel:[0,1] op_sel_hi:[1,1]
  v_exp_f32 v30, v30 clamp
  v_exp_f32 v31, v31 clamp
  v_max_f32 v102, s32, v102
  v_max_f32 v103, s32, v103
  v_pk_add_f32 v[102:103], v[102:103], v[30:31]
  v_cvt_pk_bf16_f32 v19, v102, v103
  s_add_u32 s48, s49, 3145728
  buffer_store_dwordx4 v[16:19], v1, s[4:7], s48 offen offset:0 sc0 sc1
  v_pk_fma_f32 v[104:105], v[104:105], v[24:25], s[32:33] op_sel_hi:[1,0,0]
  v_pk_mul_f32 v[28:29], v[104:105], s[32:33] op_sel:[0,1] op_sel_hi:[1,1]
  v_exp_f32 v28, v28 clamp
  v_exp_f32 v29, v29 clamp
  v_max_f32 v104, s32, v104
  v_max_f32 v105, s32, v105
  v_pk_add_f32 v[104:105], v[104:105], v[28:29]
  v_cvt_pk_bf16_f32 v20, v104, v105
  v_pk_fma_f32 v[106:107], v[106:107], v[24:25], s[32:33] op_sel_hi:[1,0,0]
  v_pk_mul_f32 v[30:31], v[106:107], s[32:33] op_sel:[0,1] op_sel_hi:[1,1]
  v_exp_f32 v30, v30 clamp
  v_exp_f32 v31, v31 clamp
  v_max_f32 v106, s32, v106
  v_max_f32 v107, s32, v107
  v_pk_add_f32 v[106:107], v[106:107], v[30:31]
  v_cvt_pk_bf16_f32 v21, v106, v107
  v_pk_fma_f32 v[108:109], v[108:109], v[24:25], s[32:33] op_sel_hi:[1,0,0]
  v_pk_mul_f32 v[28:29], v[108:109], s[32:33] op_sel:[0,1] op_sel_hi:[1,1]
  v_exp_f32 v28, v28 clamp
  v_exp_f32 v29, v29 clamp
  v_max_f32 v108, s32, v108
  v_max_f32 v109, s32, v109
  v_pk_add_f32 v[108:109], v[108:109], v[28:29]
  v_cvt_pk_bf16_f32 v22, v108, v109
  v_pk_fma_f32 v[110:111], v[110:111], v[24:25], s[32:33] op_sel_hi:[1,0,0]
  v_pk_mul_f32 v[30:31], v[110:111], s[32:33] op_sel:[0,1] op_sel_hi:[1,1]
  v_exp_f32 v30, v30 clamp
  v_exp_f32 v31, v31 clamp
  v_max_f32 v110, s32, v110
  v_max_f32 v111, s32, v111
  v_pk_add_f32 v[110:111], v[110:111], v[30:31]
  v_cvt_pk_bf16_f32 v23, v110, v111
  buffer_store_dwordx4 v[20:23], v1, s[4:7], s48 offen offset:1024 sc0 sc1
  s_branch M_wo
M_done:
M_exit:
  s_endpgm
.section .rodata,"a"
.p2align 6
.amdhsa_kernel interleave_layers__linear_attn_block__glu_gated_bilinear__prompt_kernel
  .amdhsa_next_free_vgpr 512
  .amdhsa_next_free_sgpr 102
  .amdhsa_accum_offset 256
  .amdhsa_group_segment_fixed_size 0
  .amdhsa_kernarg_size 80
  .amdhsa_user_sgpr_count 2
  .amdhsa_user_sgpr_kernarg_segment_ptr 1
  .amdhsa_system_sgpr_workgroup_id_x 1
.end_amdhsa_kernel
```
